```python
import torch

def _softmax(x, axis=-1):
    return torch.softmax(x, dim=axis)
def _gelu(x):
    return torch.nn.functional.gelu(x, approximate="tanh")
def _silu(x):
    return torch.nn.functional.silu(x)
def _sigmoid(x):
    return torch.sigmoid(x)
def _layernorm(x, axis=-1, eps=1e-5):
    m = x.mean(dim=axis, keepdim=True)
    v = x.var(dim=axis, keepdim=True, unbiased=False)
    return (x - m) / torch.sqrt(v + eps)
def _scatter_add(tgt, idx, src, axis=0):
    return tgt.clone().index_add_(axis, idx, src)
def _segment_sum(src, seg, n):
    out = torch.zeros((n,) + src.shape[1:], dtype=src.dtype)
    return out.index_add_(0, seg, src)
def _pad(x, pw):
    flat = tuple(v for pair in reversed(pw) for v in pair)
    return torch.nn.functional.pad(x, flat)

kernel_name = 'recurrent_scan__mha_block_cached__dense_activation_gelu__decode'

def setup_inputs():

    _w = (lambda a: (lambda t: t.to(torch.bfloat16) if t.is_floating_point() else t)(torch.as_tensor(a)))
    def _A_setup():
        B, Sq, D = 8, 1, 640
        H, Sk, Dh = 32, 4096, 128
        return {
            "x": _w((lambda *s: torch.randn(*s, dtype=torch.bfloat16) * 0.1)(B, Sq, D)),
            "k_cache": _w((lambda *s: torch.randn(*s, dtype=torch.bfloat16) * 0.8)(B, H, Sk, Dh)),
            "v_cache": _w((lambda *s: torch.randn(*s, dtype=torch.bfloat16) * 3.2)(B, H, Sk, Dh)),
            "wq": _w((lambda *s: torch.randn(*s, dtype=torch.bfloat16) * 0.8)(D, H * Dh) * (D ** -0.5)),
            "wo": _w((lambda *s: torch.randn(*s, dtype=torch.bfloat16) * 3.2)(H * Dh, D) * ((H * Dh) ** -0.5)),
        }
    _A_in = _A_setup()

    def _B_setup():
        B, S, D, F = 8, 1, 640, 1728
        return {
            "x": _w((lambda *s: torch.randn(*s, dtype=torch.bfloat16) * 0.1)(B, S, D)),
            "w1": _w((lambda *s: torch.randn(*s, dtype=torch.bfloat16) * 3.2)(D, F) * (D ** -0.5)),
            "b1": _w((lambda *s: torch.randn(*s, dtype=torch.bfloat16) * 3.2)(F) * 0.01),
            "w2": _w((lambda *s: torch.randn(*s, dtype=torch.bfloat16) * 3.2)(F, D) * (F ** -0.5)),
            "b2": _w((lambda *s: torch.randn(*s, dtype=torch.bfloat16) * 3.2)(D) * 0.01),
        }
    _B_in = _B_setup()

    return {
        "A_x": _A_in["x"],
        "A_k_cache": _A_in["k_cache"],
        "A_v_cache": _A_in["v_cache"],
        "A_wq": _A_in["wq"],
        "A_wo": _A_in["wo"],
        "B_x": _B_in["x"],
        "B_w1": _B_in["w1"],
        "B_b1": _B_in["b1"],
        "B_w2": _B_in["w2"],
        "B_b2": _B_in["b2"],
    }

def reference(A_x, A_k_cache, A_v_cache, A_wq, A_wo, B_x, B_w1, B_b1, B_w2, B_b2):
    def _A_ref(x, k_cache, v_cache, wq, wo):
        B, Sq, D = x.shape
        H, Dh = 32, 128
        q = (lambda x, *d: x.permute(*d))((x @ wq).reshape(B, Sq, H, Dh), 0, 2, 1, 3)
        scores = torch.einsum("bhqd,bhkd->bhqk", q, k_cache) * (Dh ** -0.5)
        p = _softmax(scores, axis=-1)
        o = torch.einsum("bhqk,bhkd->bhqd", p, v_cache)
        return (lambda x, *d: x.permute(*d))(o, 0, 2, 1, 3).reshape(B, Sq, H * Dh) @ wo

    def _B_ref(x, w1, b1, w2, b2):
        h = torch.einsum("bsd,df->bsf", x, w1) + b1
        h = _gelu(h)
        return torch.einsum("bsf,fd->bsd", h, w2) + b2

    x = A_x
    xn = _layernorm(x, axis=-1)
    s = _A_ref(xn, A_k_cache, A_v_cache, A_wq, A_wo)
    g = _silu(_B_ref(xn, B_w1, B_b1, B_w2, B_b2))
    return x + s * g
```

```asm
; @launch kernel=attn_ffn_kernel grid=(256,1,1) block=(512,1,1) lds=101376
; @launch kernel=final_kernel grid=(80,1,1) block=(256,1,1) lds=8192
.amdgcn_target "amdgcn-amd-amdhsa--gfx950"
.text
.globl attn_ffn_kernel
.p2align 8
.type attn_ffn_kernel,@function
attn_ffn_kernel:
    s_cmp_ge_u32 s2, 256
    s_cbranch_scc1 L_a_end
    s_load_dwordx16 s[4:19], s[0:1], 0
    s_load_dwordx8 s[20:27], s[0:1], 64
    s_load_dwordx2 s[28:29], s[0:1], 96
    v_and_b32 v1, 63, v0
    v_lshrrev_b32 v122, 6, v0
    v_and_b32 v2, 15, v1
    v_readfirstlane_b32 s72, v122
    v_lshrrev_b32 v3, 4, v1
    v_and_b32 v122, 7, v1
    v_and_b32 v123, 1, v1
    v_cmp_eq_u32 vcc, 1, v123
    v_mov_b32 v124, 0x0000ffff
    v_mov_b32 v125, 0xffff0000
    s_nop 1
    v_cndmask_b32 v123, v124, v125, vcc
    v_lshrrev_b32 v122, 1, v122
    v_cmp_eq_u32 vcc, 0, v122
    s_nop 1
    v_cndmask_b32 v8, 0, v123, vcc
    v_cmp_eq_u32 vcc, 1, v122
    s_nop 1
    v_cndmask_b32 v9, 0, v123, vcc
    v_cmp_eq_u32 vcc, 2, v122
    s_nop 1
    v_cndmask_b32 v10, 0, v123, vcc
    v_cmp_eq_u32 vcc, 3, v122
    s_nop 1
    v_cndmask_b32 v11, 0, v123, vcc
    s_mov_b32 s77, 0x3e0293ee
    s_lshr_b32 s79, s2, 5
    s_and_b32 s80, s2, 31
    s_mov_b32 s86, s2
    v_lshlrev_b32 v4, 4, v1
    v_add_u32 v5, 4096, v4
    v_and_b32 v124, 3, v2
    v_lshrrev_b32 v125, 2, v2
    v_lshl_add_u32 v124, v124, 2, v125
    v_lshlrev_b32 v124, 8, v124
    v_lshl_add_u32 v6, v3, 4, v124
    v_add_u32 v7, 4096, v6
    v_mul_u32_u24 v126, 5120, v3
    v_lshl_add_u32 v126, v2, 4, v126
    v_add_u32 v127, 2560, v126
    v_mul_u32_u24 v123, 163840, v3
    v_lshl_add_u32 v123, v2, 4, v123
    v_lshlrev_b32 v122, 2, v1
    v_mov_b32 v124, 39232
    v_mov_b32 v125, 8
    ds_write_b32 v124, v125
    s_mul_i32 s76, s72, 20480
    s_lshl_b32 s78, s72, 13
    s_waitcnt lgkmcnt(0)
    s_mov_b32 s48, s4
    s_and_b32 s49, s5, 0xffff
    s_mov_b32 s50, 10240
    s_mov_b32 s51, 0x00020000
    s_cmp_ge_u32 s86, 108
    s_cbranch_scc1 L_nodma
    s_cmp_ge_u32 s72, 4
    s_cbranch_scc1 L_dma2
    s_mov_b32 s56, s16
    s_and_b32 s57, s17, 0xffff
    s_mov_b32 s58, 2211840
    s_mov_b32 s59, 0x00020000
    v_lshrrev_b32 v124, 1, v1
    v_mul_u32_u24 v124, 3456, v124
    v_and_b32 v125, 1, v1
    v_lshl_add_u32 v124, v125, 4, v124
    s_mul_i32 s73, s72, 552960
    s_lshl_b32 s74, s86, 5
    s_add_u32 s73, s73, s74
    s_mul_i32 s74, s72, 5120
    s_add_u32 s74, s74, 60416
    s_mov_b32 m0, s74
    s_nop 0
    buffer_load_dwordx4 v124, s[56:59], s73 offen lds
    s_add_u32 s73, s73, 110592
    s_add_u32 s74, s74, 1024
    s_mov_b32 m0, s74
    s_nop 0
    buffer_load_dwordx4 v124, s[56:59], s73 offen lds
    s_add_u32 s73, s73, 110592
    s_add_u32 s74, s74, 1024
    s_mov_b32 m0, s74
    s_nop 0
    buffer_load_dwordx4 v124, s[56:59], s73 offen lds
    s_add_u32 s73, s73, 110592
    s_add_u32 s74, s74, 1024
    s_mov_b32 m0, s74
    s_nop 0
    buffer_load_dwordx4 v124, s[56:59], s73 offen lds
    s_add_u32 s73, s73, 110592
    s_add_u32 s74, s74, 1024
    s_mov_b32 m0, s74
    s_nop 0
    buffer_load_dwordx4 v124, s[56:59], s73 offen lds
    s_add_u32 s73, s73, 110592
    s_add_u32 s74, s74, 1024
    s_branch L_nodma
L_dma2:
    s_mov_b32 s60, s20
    s_and_b32 s61, s21, 0xffff
    s_mov_b32 s62, 2211840
    s_mov_b32 s63, 0x00020000
    s_sub_u32 s75, s72, 4
    s_mul_i32 s73, s75, 1280
    v_add_u32 v124, s73, v126
    s_mul_i32 s73, s86, 20480
    s_mul_i32 s74, s75, 5120
    s_add_u32 s74, s74, 80896
    s_mov_b32 m0, s74
    s_nop 0
    buffer_load_dwordx4 v124, s[60:63], s73 offen lds
    s_add_u32 s73, s73, 256
    s_add_u32 s74, s74, 1024
    s_mov_b32 m0, s74
    s_nop 0
    buffer_load_dwordx4 v124, s[60:63], s73 offen lds
    s_add_u32 s73, s73, 256
    s_add_u32 s74, s74, 1024
    s_mov_b32 m0, s74
    s_nop 0
    buffer_load_dwordx4 v124, s[60:63], s73 offen lds
    s_add_u32 s73, s73, 256
    s_add_u32 s74, s74, 1024
    s_mov_b32 m0, s74
    s_nop 0
    buffer_load_dwordx4 v124, s[60:63], s73 offen lds
    s_add_u32 s73, s73, 256
    s_add_u32 s74, s74, 1024
    s_mov_b32 m0, s74
    s_nop 0
    buffer_load_dwordx4 v124, s[60:63], s73 offen lds
    s_add_u32 s73, s73, 256
    s_add_u32 s74, s74, 1024
L_nodma:
    s_mov_b32 s64, s18
    s_and_b32 s65, s19, 0xffff
    s_mov_b32 s66, 3456
    s_mov_b32 s67, 0x00020000
    v_lshlrev_b32 v124, 1, v2
    s_lshl_b32 s73, s86, 5
    buffer_load_ushort v255, v124, s[64:67], s73 offen
    s_mul_i32 s73, s72, 1280
    buffer_load_dword v208, v122, s[48:51], s73 offen offset:0
    buffer_load_dword v209, v122, s[48:51], s73 offen offset:256
    buffer_load_dword v210, v122, s[48:51], s73 offen offset:512
    buffer_load_dword v211, v122, s[48:51], s73 offen offset:768
    buffer_load_dword v212, v122, s[48:51], s73 offen offset:1024
    s_mov_b32 s40, s10
    s_and_b32 s41, s11, 0xffff
    s_mov_b32 s42, 5242880
    s_mov_b32 s43, 0x00020000
    s_mul_i32 s74, s72, 655360
    s_lshl_b32 s75, s80, 8
    s_add_u32 s74, s74, s75
    s_lshl_b32 s73, s2, 20
    s_add_u32 s32, s6, s73
    s_addc_u32 s33, s7, 0
    s_and_b32 s33, s33, 0xffff
    s_mov_b32 s34, 1048576
    s_mov_b32 s35, 0x00020000
    s_add_u32 s36, s8, s73
    s_addc_u32 s37, s9, 0
    s_and_b32 s37, s37, 0xffff
    s_mov_b32 s38, 1048576
    s_mov_b32 s39, 0x00020000
    s_mul_i32 s73, s80, 163840
    s_add_u32 s44, s12, s73
    s_addc_u32 s45, s13, 0
    s_and_b32 s45, s45, 0xffff
    s_mov_b32 s46, 163840
    s_mov_b32 s47, 0x00020000
    s_mul_i32 s73, s2, 2560
    s_add_u32 s52, s28, s73
    s_addc_u32 s53, s29, 0
    s_and_b32 s53, s53, 0xffff
    s_mov_b32 s54, 2560
    s_mov_b32 s55, 0x00020000
    buffer_load_dwordx4 v[128:131], v123, s[40:43], s74 offen
    s_add_u32 s74, s74, 8192
    buffer_load_dwordx4 v[132:135], v123, s[40:43], s74 offen
    s_add_u32 s74, s74, 8192
    buffer_load_dwordx4 v[136:139], v123, s[40:43], s74 offen
    s_add_u32 s74, s74, 8192
    buffer_load_dwordx4 v[140:143], v123, s[40:43], s74 offen
    s_add_u32 s74, s74, 8192
    buffer_load_dwordx4 v[144:147], v123, s[40:43], s74 offen
    s_add_u32 s74, s74, 8192
    buffer_load_dwordx4 v[148:151], v123, s[40:43], s74 offen
    s_add_u32 s74, s74, 8192
    buffer_load_dwordx4 v[152:155], v123, s[40:43], s74 offen
    s_add_u32 s74, s74, 8192
    buffer_load_dwordx4 v[156:159], v123, s[40:43], s74 offen
    s_add_u32 s74, s74, 8192
    buffer_load_dwordx4 v[160:163], v123, s[40:43], s74 offen
    s_add_u32 s74, s74, 8192
    buffer_load_dwordx4 v[164:167], v123, s[40:43], s74 offen
    s_add_u32 s74, s74, 8192
    buffer_load_dwordx4 v[168:171], v123, s[40:43], s74 offen
    s_add_u32 s74, s74, 8192
    buffer_load_dwordx4 v[172:175], v123, s[40:43], s74 offen
    s_add_u32 s74, s74, 8192
    buffer_load_dwordx4 v[176:179], v123, s[40:43], s74 offen
    s_add_u32 s74, s74, 8192
    buffer_load_dwordx4 v[180:183], v123, s[40:43], s74 offen
    s_add_u32 s74, s74, 8192
    buffer_load_dwordx4 v[184:187], v123, s[40:43], s74 offen
    s_add_u32 s74, s74, 8192
    buffer_load_dwordx4 v[188:191], v123, s[40:43], s74 offen
    s_add_u32 s74, s74, 8192
    buffer_load_dwordx4 v[192:195], v123, s[40:43], s74 offen
    s_add_u32 s74, s74, 8192
    buffer_load_dwordx4 v[196:199], v123, s[40:43], s74 offen
    s_add_u32 s74, s74, 8192
    buffer_load_dwordx4 v[200:203], v123, s[40:43], s74 offen
    s_add_u32 s74, s74, 8192
    buffer_load_dwordx4 v[204:207], v123, s[40:43], s74 offen
    s_add_u32 s74, s74, 8192
    s_barrier
    buffer_load_dwordx4 v[32:35], v6, s[32:35], s78 offen offset:0 sc1 nt
    buffer_load_dwordx4 v[36:39], v6, s[32:35], s78 offen offset:64 sc1 nt
    buffer_load_dwordx4 v[40:43], v6, s[32:35], s78 offen offset:128 sc1 nt
    buffer_load_dwordx4 v[44:47], v6, s[32:35], s78 offen offset:192 sc1 nt
    buffer_load_dwordx4 v[48:51], v7, s[32:35], s78 offen offset:0 sc1 nt
    buffer_load_dwordx4 v[52:55], v7, s[32:35], s78 offen offset:64 sc1 nt
    buffer_load_dwordx4 v[56:59], v7, s[32:35], s78 offen offset:128 sc1 nt
    buffer_load_dwordx4 v[60:63], v7, s[32:35], s78 offen offset:192 sc1 nt
    buffer_load_dwordx4 v[64:67], v4, s[36:39], s78 offen offset:0 sc1 nt
    buffer_load_dwordx4 v[68:71], v4, s[36:39], s78 offen offset:1024 sc1 nt
    buffer_load_dwordx4 v[72:75], v4, s[36:39], s78 offen offset:2048 sc1 nt
    buffer_load_dwordx4 v[76:79], v4, s[36:39], s78 offen offset:3072 sc1 nt
    buffer_load_dwordx4 v[80:83], v5, s[36:39], s78 offen offset:0 sc1 nt
    buffer_load_dwordx4 v[84:87], v5, s[36:39], s78 offen offset:1024 sc1 nt
    buffer_load_dwordx4 v[88:91], v5, s[36:39], s78 offen offset:2048 sc1 nt
    buffer_load_dwordx4 v[92:95], v5, s[36:39], s78 offen offset:3072 sc1 nt
    s_waitcnt vmcnt(36)
    v_lshlrev_b32 v214, 16, v208
    v_and_b32 v215, 0xffff0000, v208
    v_lshlrev_b32 v216, 16, v209
    v_and_b32 v217, 0xffff0000, v209
    v_lshlrev_b32 v218, 16, v210
    v_and_b32 v219, 0xffff0000, v210
    v_lshlrev_b32 v220, 16, v211
    v_and_b32 v221, 0xffff0000, v211
    v_lshlrev_b32 v222, 16, v212
    v_and_b32 v223, 0xffff0000, v212
    v_add_f32 v124, v214, v215
    v_add_f32 v124, v124, v216
    v_add_f32 v124, v124, v217
    v_add_f32 v124, v124, v218
    v_add_f32 v124, v124, v219
    v_add_f32 v124, v124, v220
    v_add_f32 v124, v124, v221
    v_add_f32 v124, v124, v222
    v_add_f32 v124, v124, v223
    s_nop 1
    v_add_f32_dpp v124, v124, v124 quad_perm:[1,0,3,2] row_mask:0xf bank_mask:0xf
    s_nop 1
    v_add_f32_dpp v124, v124, v124 quad_perm:[2,3,0,1] row_mask:0xf bank_mask:0xf
    s_nop 1
    v_add_f32_dpp v124, v124, v124 row_half_mirror row_mask:0xf bank_mask:0xf
    s_nop 1
    v_add_f32_dpp v124, v124, v124 row_mirror row_mask:0xf bank_mask:0xf
    s_nop 1
    v_mov_b32 v125, v124
    s_nop 1
    v_permlane16_swap_b32 v124, v125
    s_nop 0
    v_add_f32 v124, v124, v125
    v_mov_b32 v125, v124
    s_nop 1
    v_permlane32_swap_b32 v124, v125
    s_nop 0
    v_add_f32 v124, v124, v125
    v_mul_f32 v124, 0x3acccccd, v124
    v_sub_f32 v224, v214, v124
    v_mul_f32 v125, v224, v224
    v_sub_f32 v224, v215, v124
    v_fmac_f32 v125, v224, v224
    v_sub_f32 v224, v216, v124
    v_fmac_f32 v125, v224, v224
    v_sub_f32 v224, v217, v124
    v_fmac_f32 v125, v224, v224
    v_sub_f32 v224, v218, v124
    v_fmac_f32 v125, v224, v224
    v_sub_f32 v224, v219, v124
    v_fmac_f32 v125, v224, v224
    v_sub_f32 v224, v220, v124
    v_fmac_f32 v125, v224, v224
    v_sub_f32 v224, v221, v124
    v_fmac_f32 v125, v224, v224
    v_sub_f32 v224, v222, v124
    v_fmac_f32 v125, v224, v224
    v_sub_f32 v224, v223, v124
    v_fmac_f32 v125, v224, v224
    s_nop 1
    v_add_f32_dpp v125, v125, v125 quad_perm:[1,0,3,2] row_mask:0xf bank_mask:0xf
    s_nop 1
    v_add_f32_dpp v125, v125, v125 quad_perm:[2,3,0,1] row_mask:0xf bank_mask:0xf
    s_nop 1
    v_add_f32_dpp v125, v125, v125 row_half_mirror row_mask:0xf bank_mask:0xf
    s_nop 1
    v_add_f32_dpp v125, v125, v125 row_mirror row_mask:0xf bank_mask:0xf
    s_nop 1
    v_mov_b32 v224, v125
    s_nop 1
    v_permlane16_swap_b32 v125, v224
    s_nop 0
    v_add_f32 v125, v125, v224
    v_mov_b32 v224, v125
    s_nop 1
    v_permlane32_swap_b32 v125, v224
    s_nop 0
    v_add_f32 v125, v125, v224
    v_mul_f32 v125, 0x3acccccd, v125
    v_cvt_pk_bf16_f32 v124, v124, v124
    v_and_b32 v124, 0xffff0000, v124
    v_cvt_pk_bf16_f32 v125, v125, v125
    v_and_b32 v125, 0xffff0000, v125
    v_add_f32 v125, 0x3727c5ac, v125
    v_cvt_pk_bf16_f32 v125, v125, v125
    v_and_b32 v125, 0xffff0000, v125
    v_sqrt_f32 v125, v125
    s_nop 0
    v_cvt_pk_bf16_f32 v125, v125, v125
    v_and_b32 v125, 0xffff0000, v125
    v_rcp_f32 v224, v125
    s_nop 0
    v_fma_f32 v225, -v125, v224, 2.0
    v_mul_f32 v224, v224, v225
    v_sub_f32 v214, v214, v124
    v_cvt_pk_bf16_f32 v214, v214, v214
    v_and_b32 v214, 0xffff0000, v214
    v_mul_f32 v214, v214, v224
    v_sub_f32 v215, v215, v124
    v_cvt_pk_bf16_f32 v215, v215, v215
    v_and_b32 v215, 0xffff0000, v215
    v_mul_f32 v215, v215, v224
    v_sub_f32 v216, v216, v124
    v_cvt_pk_bf16_f32 v216, v216, v216
    v_and_b32 v216, 0xffff0000, v216
    v_mul_f32 v216, v216, v224
    v_sub_f32 v217, v217, v124
    v_cvt_pk_bf16_f32 v217, v217, v217
    v_and_b32 v217, 0xffff0000, v217
    v_mul_f32 v217, v217, v224
    v_sub_f32 v218, v218, v124
    v_cvt_pk_bf16_f32 v218, v218, v218
    v_and_b32 v218, 0xffff0000, v218
    v_mul_f32 v218, v218, v224
    v_sub_f32 v219, v219, v124
    v_cvt_pk_bf16_f32 v219, v219, v219
    v_and_b32 v219, 0xffff0000, v219
    v_mul_f32 v219, v219, v224
    v_sub_f32 v220, v220, v124
    v_cvt_pk_bf16_f32 v220, v220, v220
    v_and_b32 v220, 0xffff0000, v220
    v_mul_f32 v220, v220, v224
    v_sub_f32 v221, v221, v124
    v_cvt_pk_bf16_f32 v221, v221, v221
    v_and_b32 v221, 0xffff0000, v221
    v_mul_f32 v221, v221, v224
    v_sub_f32 v222, v222, v124
    v_cvt_pk_bf16_f32 v222, v222, v222
    v_and_b32 v222, 0xffff0000, v222
    v_mul_f32 v222, v222, v224
    v_sub_f32 v223, v223, v124
    v_cvt_pk_bf16_f32 v223, v223, v223
    v_and_b32 v223, 0xffff0000, v223
    v_mul_f32 v223, v223, v224
    s_mul_i32 s73, s72, 1280
    v_add_u32 v124, s73, v122
    v_cvt_pk_bf16_f32 v208, v214, v215
    ds_write_b32 v124, v208 offset:20480
    v_cvt_pk_bf16_f32 v209, v216, v217
    ds_write_b32 v124, v209 offset:20736
    v_cvt_pk_bf16_f32 v210, v218, v219
    ds_write_b32 v124, v210 offset:20992
    v_cvt_pk_bf16_f32 v211, v220, v221
    ds_write_b32 v124, v211 offset:21248
    v_cvt_pk_bf16_f32 v212, v222, v223
    ds_write_b32 v124, v212 offset:21504
    v_lshlrev_b32 v124, 1, v124
    v_cvt_pk_bf16_f32 v214, v214, v214
    v_cvt_pk_bf16_f32 v215, v215, v215
    v_cvt_pk_bf16_f32 v216, v216, v216
    v_cvt_pk_bf16_f32 v217, v217, v217
    v_cvt_pk_bf16_f32 v218, v218, v218
    v_cvt_pk_bf16_f32 v219, v219, v219
    v_cvt_pk_bf16_f32 v220, v220, v220
    v_cvt_pk_bf16_f32 v221, v221, v221
    v_cvt_pk_bf16_f32 v222, v222, v222
    v_cvt_pk_bf16_f32 v223, v223, v223
    ds_write_b64 v124, v[214:215] offset:0
    ds_write_b64 v124, v[216:217] offset:512
    ds_write_b64 v124, v[218:219] offset:1024
    ds_write_b64 v124, v[220:221] offset:1536
    ds_write_b64 v124, v[222:223] offset:2048
    v_mul_u32_u24 v122, 80, v3
    s_mul_i32 s75, s72, 320
    s_mul_i32 s73, s79, 2560
    s_add_u32 s75, s75, s73
    v_add_u32 v122, s75, v122
    s_waitcnt lgkmcnt(0)
    s_barrier
    ds_read_b128 v[228:231], v122 offset:0
    ds_read_b128 v[232:235], v122 offset:16
    ds_read_b128 v[236:239], v122 offset:32
    ds_read_b128 v[240:243], v122 offset:48
    ds_read_b128 v[244:247], v122 offset:64
    s_waitcnt vmcnt(16) lgkmcnt(0)
    v_and_b32 v104, v228, v8
    v_and_b32 v105, v228, v9
    v_and_b32 v106, v228, v10
    v_and_b32 v107, v228, v11
    v_and_b32 v108, v229, v8
    v_and_b32 v109, v229, v9
    v_and_b32 v110, v229, v10
    v_and_b32 v111, v229, v11
    v_mfma_f32_16x16x32_bf16 v[12:15], v[104:107], v[128:131], 0
    v_and_b32 v112, v230, v8
    v_and_b32 v113, v230, v9
    v_and_b32 v114, v230, v10
    v_and_b32 v115, v230, v11
    v_mfma_f32_16x16x32_bf16 v[12:15], v[108:111], v[132:135], v[12:15]
    v_and_b32 v116, v231, v8
    v_and_b32 v117, v231, v9
    v_and_b32 v118, v231, v10
    v_and_b32 v119, v231, v11
    v_mfma_f32_16x16x32_bf16 v[12:15], v[112:115], v[136:139], v[12:15]
    v_and_b32 v104, v232, v8
    v_and_b32 v105, v232, v9
    v_and_b32 v106, v232, v10
    v_and_b32 v107, v232, v11
    v_mfma_f32_16x16x32_bf16 v[12:15], v[116:119], v[140:143], v[12:15]
    v_and_b32 v108, v233, v8
    v_and_b32 v109, v233, v9
    v_and_b32 v110, v233, v10
    v_and_b32 v111, v233, v11
    v_mfma_f32_16x16x32_bf16 v[12:15], v[104:107], v[144:147], v[12:15]
    v_and_b32 v112, v234, v8
    v_and_b32 v113, v234, v9
    v_and_b32 v114, v234, v10
    v_and_b32 v115, v234, v11
    v_mfma_f32_16x16x32_bf16 v[12:15], v[108:111], v[148:151], v[12:15]
    v_and_b32 v116, v235, v8
    v_and_b32 v117, v235, v9
    v_and_b32 v118, v235, v10
    v_and_b32 v119, v235, v11
    v_mfma_f32_16x16x32_bf16 v[12:15], v[112:115], v[152:155], v[12:15]
    v_and_b32 v104, v236, v8
    v_and_b32 v105, v236, v9
    v_and_b32 v106, v236, v10
    v_and_b32 v107, v236, v11
    v_mfma_f32_16x16x32_bf16 v[12:15], v[116:119], v[156:159], v[12:15]
    v_and_b32 v108, v237, v8
    v_and_b32 v109, v237, v9
    v_and_b32 v110, v237, v10
    v_and_b32 v111, v237, v11
    v_mfma_f32_16x16x32_bf16 v[12:15], v[104:107], v[160:163], v[12:15]
    v_and_b32 v112, v238, v8
    v_and_b32 v113, v238, v9
    v_and_b32 v114, v238, v10
    v_and_b32 v115, v238, v11
    v_mfma_f32_16x16x32_bf16 v[12:15], v[108:111], v[164:167], v[12:15]
    v_and_b32 v116, v239, v8
    v_and_b32 v117, v239, v9
    v_and_b32 v118, v239, v10
    v_and_b32 v119, v239, v11
    v_mfma_f32_16x16x32_bf16 v[12:15], v[112:115], v[168:171], v[12:15]
    v_and_b32 v104, v240, v8
    v_and_b32 v105, v240, v9
    v_and_b32 v106, v240, v10
    v_and_b32 v107, v240, v11
    v_mfma_f32_16x16x32_bf16 v[12:15], v[116:119], v[172:175], v[12:15]
    v_and_b32 v108, v241, v8
    v_and_b32 v109, v241, v9
    v_and_b32 v110, v241, v10
    v_and_b32 v111, v241, v11
    v_mfma_f32_16x16x32_bf16 v[12:15], v[104:107], v[176:179], v[12:15]
    v_and_b32 v112, v242, v8
    v_and_b32 v113, v242, v9
    v_and_b32 v114, v242, v10
    v_and_b32 v115, v242, v11
    v_mfma_f32_16x16x32_bf16 v[12:15], v[108:111], v[180:183], v[12:15]
    v_and_b32 v116, v243, v8
    v_and_b32 v117, v243, v9
    v_and_b32 v118, v243, v10
    v_and_b32 v119, v243, v11
    v_mfma_f32_16x16x32_bf16 v[12:15], v[112:115], v[184:187], v[12:15]
    v_and_b32 v104, v244, v8
    v_and_b32 v105, v244, v9
    v_and_b32 v106, v244, v10
    v_and_b32 v107, v244, v11
    v_mfma_f32_16x16x32_bf16 v[12:15], v[116:119], v[188:191], v[12:15]
    v_and_b32 v108, v245, v8
    v_and_b32 v109, v245, v9
    v_and_b32 v110, v245, v10
    v_and_b32 v111, v245, v11
    v_mfma_f32_16x16x32_bf16 v[12:15], v[104:107], v[192:195], v[12:15]
    v_and_b32 v112, v246, v8
    v_and_b32 v113, v246, v9
    v_and_b32 v114, v246, v10
    v_and_b32 v115, v246, v11
    v_mfma_f32_16x16x32_bf16 v[12:15], v[108:111], v[196:199], v[12:15]
    v_and_b32 v116, v247, v8
    v_and_b32 v117, v247, v9
    v_and_b32 v118, v247, v10
    v_and_b32 v119, v247, v11
    v_mfma_f32_16x16x32_bf16 v[12:15], v[112:115], v[200:203], v[12:15]
    s_nop 1
    v_mfma_f32_16x16x32_bf16 v[12:15], v[116:119], v[204:207], v[12:15]
    v_and_b32 v122, 1, v3
    v_lshlrev_b32 v122, 4, v122
    v_lshl_add_u32 v122, v2, 5, v122
    s_lshl_b32 s75, s72, 9
    v_add_u32 v122, s75, v122
    s_nop 4
    ds_write_b128 v122, v[12:15] offset:30720
    s_waitcnt lgkmcnt(0)
    s_barrier
    v_and_b32 v122, 127, v0
    v_lshlrev_b32 v123, 2, v122
    ds_read_b32 v96, v123 offset:30720
    ds_read_b32 v97, v123 offset:31232
    ds_read_b32 v98, v123 offset:31744
    ds_read_b32 v99, v123 offset:32256
    ds_read_b32 v100, v123 offset:32768
    ds_read_b32 v101, v123 offset:33280
    ds_read_b32 v102, v123 offset:33792
    ds_read_b32 v103, v123 offset:34304
    s_waitcnt lgkmcnt(0)
    v_add_f32 v124, v96, v97
    v_add_f32 v124, v124, v98
    v_add_f32 v124, v124, v99
    v_add_f32 v124, v124, v100
    v_add_f32 v124, v124, v101
    v_add_f32 v124, v124, v102
    v_add_f32 v124, v124, v103
    v_cvt_pk_bf16_f32 v124, v124, v124
    v_lshlrev_b32 v123, 1, v122
    ds_write_b16 v123, v124 offset:34816
    s_waitcnt lgkmcnt(0)
    s_barrier
    v_lshlrev_b32 v123, 4, v3
    ds_read_b128 v[16:19], v123 offset:34816
    ds_read_b128 v[20:23], v123 offset:34880
    ds_read_b128 v[24:27], v123 offset:34944
    ds_read_b128 v[28:31], v123 offset:35008
    v_mov_b32 v120, 0xf149f2ca
    v_mov_b32 v121, 0
    v_mov_b32 v12, 0
    v_mov_b32 v13, 0
    v_mov_b32 v14, 0
    v_mov_b32 v15, 0
    s_mov_b32 s83, s72
    s_mul_i32 s82, s79, 0
    s_add_u32 s82, s82, 24
    s_waitcnt lgkmcnt(0)
    s_cmp_lg_u32 s72, 0
    s_cbranch_scc1 L_loop
    s_cmp_ge_u32 s86, 108
    s_cbranch_scc1 L_loop
    s_setprio 0
    s_mul_i32 s73, s86, 20480
    s_add_u32 s73, s73, 655360
    s_add_u32 s68, s28, s73
    s_addc_u32 s69, s29, 0
    s_and_b32 s69, s69, 0xffff
    s_mov_b32 s70, 20480
    s_mov_b32 s71, 0x00020000
    v_add_u32 v208, 80896, v4
    ds_read_b128 v[128:131], v208 offset:0
    ds_read_b128 v[132:135], v208 offset:1024
    ds_read_b128 v[136:139], v208 offset:2048
    ds_read_b128 v[140:143], v208 offset:3072
    ds_read_b128 v[144:147], v208 offset:4096
    ds_read_b128 v[148:151], v208 offset:5120
    ds_read_b128 v[152:155], v208 offset:6144
    ds_read_b128 v[156:159], v208 offset:7168
    ds_read_b128 v[160:163], v208 offset:8192
    ds_read_b128 v[164:167], v208 offset:9216
    ds_read_b128 v[168:171], v208 offset:10240
    ds_read_b128 v[172:175], v208 offset:11264
    ds_read_b128 v[176:179], v208 offset:12288
    ds_read_b128 v[180:183], v208 offset:13312
    ds_read_b128 v[184:187], v208 offset:14336
    ds_read_b128 v[188:191], v208 offset:15360
    ds_read_b128 v[192:195], v208 offset:16384
    ds_read_b128 v[196:199], v208 offset:17408
    ds_read_b128 v[200:203], v208 offset:18432
    ds_read_b128 v[204:207], v208 offset:19456
    v_and_b32 v208, 7, v1
    v_mul_u32_u24 v208, 1280, v208
    v_lshl_add_u32 v208, v3, 4, v208
    v_lshrrev_b32 v209, 2, v2
    v_lshlrev_b32 v209, 5, v209
    v_and_b32 v211, 3, v1
    v_lshl_add_u32 v209, v211, 3, v209
    v_lshl_add_u32 v209, v3, 8, v209
    v_add_u32 v209, 60416, v209
    ds_read_b128 v[216:219], v208 offset:20480
    ds_read_b64_tr_b16 v[220:221], v209 offset:0
    ds_read_b64_tr_b16 v[222:223], v209 offset:128
    ds_read_b128 v[224:227], v208 offset:20544
    ds_read_b64_tr_b16 v[228:229], v209 offset:1024
    ds_read_b64_tr_b16 v[230:231], v209 offset:1152
    ds_read_b128 v[232:235], v208 offset:20608
    ds_read_b64_tr_b16 v[236:237], v209 offset:2048
    ds_read_b64_tr_b16 v[238:239], v209 offset:2176
    ds_read_b128 v[240:243], v208 offset:20672
    ds_read_b64_tr_b16 v[244:245], v209 offset:3072
    ds_read_b64_tr_b16 v[246:247], v209 offset:3200
    s_waitcnt lgkmcnt(0)
    v_mfma_f32_16x16x32_bf16 v[212:215], v[216:219], v[220:223], 0
    v_mfma_f32_16x16x32_bf16 v[212:215], v[224:227], v[228:231], v[212:215]
    v_mfma_f32_16x16x32_bf16 v[212:215], v[232:235], v[236:239], v[212:215]
    v_mfma_f32_16x16x32_bf16 v[212:215], v[240:243], v[244:247], v[212:215]
    ds_read_b128 v[216:219], v208 offset:20736
    ds_read_b64_tr_b16 v[220:221], v209 offset:4096
    ds_read_b64_tr_b16 v[222:223], v209 offset:4224
    ds_read_b128 v[224:227], v208 offset:20800
    ds_read_b64_tr_b16 v[228:229], v209 offset:5120
    ds_read_b64_tr_b16 v[230:231], v209 offset:5248
    ds_read_b128 v[232:235], v208 offset:20864
    ds_read_b64_tr_b16 v[236:237], v209 offset:6144
    ds_read_b64_tr_b16 v[238:239], v209 offset:6272
    ds_read_b128 v[240:243], v208 offset:20928
    ds_read_b64_tr_b16 v[244:245], v209 offset:7168
    ds_read_b64_tr_b16 v[246:247], v209 offset:7296
    s_waitcnt lgkmcnt(0)
    v_mfma_f32_16x16x32_bf16 v[212:215], v[216:219], v[220:223], v[212:215]
    v_mfma_f32_16x16x32_bf16 v[212:215], v[224:227], v[228:231], v[212:215]
    v_mfma_f32_16x16x32_bf16 v[212:215], v[232:235], v[236:239], v[212:215]
    v_mfma_f32_16x16x32_bf16 v[212:215], v[240:243], v[244:247], v[212:215]
    ds_read_b128 v[216:219], v208 offset:20992
    ds_read_b64_tr_b16 v[220:221], v209 offset:8192
    ds_read_b64_tr_b16 v[222:223], v209 offset:8320
    ds_read_b128 v[224:227], v208 offset:21056
    ds_read_b64_tr_b16 v[228:229], v209 offset:9216
    ds_read_b64_tr_b16 v[230:231], v209 offset:9344
    ds_read_b128 v[232:235], v208 offset:21120
    ds_read_b64_tr_b16 v[236:237], v209 offset:10240
    ds_read_b64_tr_b16 v[238:239], v209 offset:10368
    ds_read_b128 v[240:243], v208 offset:21184
    ds_read_b64_tr_b16 v[244:245], v209 offset:11264
    ds_read_b64_tr_b16 v[246:247], v209 offset:11392
    s_waitcnt lgkmcnt(0)
    v_mfma_f32_16x16x32_bf16 v[212:215], v[216:219], v[220:223], v[212:215]
    v_mfma_f32_16x16x32_bf16 v[212:215], v[224:227], v[228:231], v[212:215]
    v_mfma_f32_16x16x32_bf16 v[212:215], v[232:235], v[236:239], v[212:215]
    v_mfma_f32_16x16x32_bf16 v[212:215], v[240:243], v[244:247], v[212:215]
    ds_read_b128 v[216:219], v208 offset:21248
    ds_read_b64_tr_b16 v[220:221], v209 offset:12288
    ds_read_b64_tr_b16 v[222:223], v209 offset:12416
    ds_read_b128 v[224:227], v208 offset:21312
    ds_read_b64_tr_b16 v[228:229], v209 offset:13312
    ds_read_b64_tr_b16 v[230:231], v209 offset:13440
    ds_read_b128 v[232:235], v208 offset:21376
    ds_read_b64_tr_b16 v[236:237], v209 offset:14336
    ds_read_b64_tr_b16 v[238:239], v209 offset:14464
    ds_read_b128 v[240:243], v208 offset:21440
    ds_read_b64_tr_b16 v[244:245], v209 offset:15360
    ds_read_b64_tr_b16 v[246:247], v209 offset:15488
    s_waitcnt lgkmcnt(0)
    v_mfma_f32_16x16x32_bf16 v[212:215], v[216:219], v[220:223], v[212:215]
    v_mfma_f32_16x16x32_bf16 v[212:215], v[224:227], v[228:231], v[212:215]
    v_mfma_f32_16x16x32_bf16 v[212:215], v[232:235], v[236:239], v[212:215]
    v_mfma_f32_16x16x32_bf16 v[212:215], v[240:243], v[244:247], v[212:215]
    ds_read_b128 v[216:219], v208 offset:21504
    ds_read_b64_tr_b16 v[220:221], v209 offset:16384
    ds_read_b64_tr_b16 v[222:223], v209 offset:16512
    ds_read_b128 v[224:227], v208 offset:21568
    ds_read_b64_tr_b16 v[228:229], v209 offset:17408
    ds_read_b64_tr_b16 v[230:231], v209 offset:17536
    ds_read_b128 v[232:235], v208 offset:21632
    ds_read_b64_tr_b16 v[236:237], v209 offset:18432
    ds_read_b64_tr_b16 v[238:239], v209 offset:18560
    ds_read_b128 v[240:243], v208 offset:21696
    ds_read_b64_tr_b16 v[244:245], v209 offset:19456
    ds_read_b64_tr_b16 v[246:247], v209 offset:19584
    s_waitcnt lgkmcnt(0)
    v_mfma_f32_16x16x32_bf16 v[212:215], v[216:219], v[220:223], v[212:215]
    v_mfma_f32_16x16x32_bf16 v[212:215], v[224:227], v[228:231], v[212:215]
    v_mfma_f32_16x16x32_bf16 v[212:215], v[232:235], v[236:239], v[212:215]
    v_mfma_f32_16x16x32_bf16 v[212:215], v[240:243], v[244:247], v[212:215]
    v_lshlrev_b32 v255, 16, v255
    v_and_b32 v208, 1, v3
    v_lshlrev_b32 v208, 8, v208
    v_lshl_add_u32 v208, v2, 2, v208
    s_nop 7
    v_cvt_pk_bf16_f32 v212, v212, v212
    v_and_b32 v212, 0xffff0000, v212
    v_add_f32 v212, v212, v255
    v_cvt_pk_bf16_f32 v212, v212, v212
    v_and_b32 v212, 0xffff0000, v212
    v_mul_f32 v216, v212, v212
    v_mul_f32 v216, 0x3d372713, v216
    v_add_f32 v216, 1.0, v216
    v_mul_f32 v216, v216, v212
    v_mul_f32 v216, 0xc0135761, v216
    v_exp_f32 v216, v216
    s_nop 0
    v_add_f32 v216, 1.0, v216
    v_rcp_f32 v216, v216
    s_nop 0
    v_mul_f32 v212, v212, v216
    v_cvt_pk_bf16_f32 v212, v212, v212
    ds_write_b32 v208, v212 offset:39296
    v_cvt_pk_bf16_f32 v213, v213, v213
    v_and_b32 v213, 0xffff0000, v213
    v_add_f32 v213, v213, v255
    v_cvt_pk_bf16_f32 v213, v213, v213
    v_and_b32 v213, 0xffff0000, v213
    v_mul_f32 v216, v213, v213
    v_mul_f32 v216, 0x3d372713, v216
    v_add_f32 v216, 1.0, v216
    v_mul_f32 v216, v216, v213
    v_mul_f32 v216, 0xc0135761, v216
    v_exp_f32 v216, v216
    s_nop 0
    v_add_f32 v216, 1.0, v216
    v_rcp_f32 v216, v216
    s_nop 0
    v_mul_f32 v213, v213, v216
    v_cvt_pk_bf16_f32 v213, v213, v213
    ds_write_b32 v208, v213 offset:39360
    v_cvt_pk_bf16_f32 v214, v214, v214
    v_and_b32 v214, 0xffff0000, v214
    v_add_f32 v214, v214, v255
    v_cvt_pk_bf16_f32 v214, v214, v214
    v_and_b32 v214, 0xffff0000, v214
    v_mul_f32 v216, v214, v214
    v_mul_f32 v216, 0x3d372713, v216
    v_add_f32 v216, 1.0, v216
    v_mul_f32 v216, v216, v214
    v_mul_f32 v216, 0xc0135761, v216
    v_exp_f32 v216, v216
    s_nop 0
    v_add_f32 v216, 1.0, v216
    v_rcp_f32 v216, v216
    s_nop 0
    v_mul_f32 v214, v214, v216
    v_cvt_pk_bf16_f32 v214, v214, v214
    ds_write_b32 v208, v214 offset:39424
    v_cvt_pk_bf16_f32 v215, v215, v215
    v_and_b32 v215, 0xffff0000, v215
    v_add_f32 v215, v215, v255
    v_cvt_pk_bf16_f32 v215, v215, v215
    v_and_b32 v215, 0xffff0000, v215
    v_mul_f32 v216, v215, v215
    v_mul_f32 v216, 0x3d372713, v216
    v_add_f32 v216, 1.0, v216
    v_mul_f32 v216, v216, v215
    v_mul_f32 v216, 0xc0135761, v216
    v_exp_f32 v216, v216
    s_nop 0
    v_add_f32 v216, 1.0, v216
    v_rcp_f32 v216, v216
    s_nop 0
    v_mul_f32 v215, v215, v216
    v_cvt_pk_bf16_f32 v215, v215, v215
    ds_write_b32 v208, v215 offset:39488
    s_waitcnt lgkmcnt(0)
    v_lshrrev_b32 v208, 3, v2
    v_lshlrev_b32 v208, 6, v208
    v_lshl_add_u32 v208, v3, 4, v208
    ds_read_b128 v[216:219], v208 offset:39296
    ds_read_b128 v[220:223], v208 offset:39424
    ds_read_b128 v[224:227], v208 offset:39552
    ds_read_b128 v[228:231], v208 offset:39680
    v_lshrrev_b32 v209, 1, v3
    v_mul_u32_u24 v209, 2560, v209
    v_lshl_add_u32 v209, v2, 5, v209
    v_and_b32 v211, 1, v3
    v_lshl_add_u32 v209, v211, 4, v209
    v_add_u32 v210, 60416, v209
    s_waitcnt lgkmcnt(0)
    v_and_b32 v212, v216, v8
    v_and_b32 v213, v216, v9
    v_and_b32 v214, v216, v10
    v_and_b32 v215, v216, v11
    s_nop 1
    v_mfma_f32_16x16x32_bf16 v[232:235], v[212:215], v[128:131], 0
    v_and_b32 v212, v220, v8
    v_and_b32 v213, v220, v9
    v_and_b32 v214, v220, v10
    v_and_b32 v215, v220, v11
    s_nop 1
    v_mfma_f32_16x16x32_bf16 v[236:239], v[212:215], v[128:131], 0
    v_and_b32 v212, v224, v8
    v_and_b32 v213, v224, v9
    v_and_b32 v214, v224, v10
    v_and_b32 v215, v224, v11
    s_nop 1
    v_mfma_f32_16x16x32_bf16 v[240:243], v[212:215], v[128:131], 0
    v_and_b32 v212, v228, v8
    v_and_b32 v213, v228, v9
    v_and_b32 v214, v228, v10
    v_and_b32 v215, v228, v11
    s_nop 1
    v_mfma_f32_16x16x32_bf16 v[244:247], v[212:215], v[128:131], 0
    v_and_b32 v212, v217, v8
    v_and_b32 v213, v217, v9
    v_and_b32 v214, v217, v10
    v_and_b32 v215, v217, v11
    s_nop 1
    v_mfma_f32_16x16x32_bf16 v[232:235], v[212:215], v[148:151], v[232:235]
    v_and_b32 v212, v221, v8
    v_and_b32 v213, v221, v9
    v_and_b32 v214, v221, v10
    v_and_b32 v215, v221, v11
    s_nop 1
    v_mfma_f32_16x16x32_bf16 v[236:239], v[212:215], v[148:151], v[236:239]
    v_and_b32 v212, v225, v8
    v_and_b32 v213, v225, v9
    v_and_b32 v214, v225, v10
    v_and_b32 v215, v225, v11
    s_nop 1
    v_mfma_f32_16x16x32_bf16 v[240:243], v[212:215], v[148:151], v[240:243]
    v_and_b32 v212, v229, v8
    v_and_b32 v213, v229, v9
    v_and_b32 v214, v229, v10
    v_and_b32 v215, v229, v11
    s_nop 1
    v_mfma_f32_16x16x32_bf16 v[244:247], v[212:215], v[148:151], v[244:247]
    v_and_b32 v212, v218, v8
    v_and_b32 v213, v218, v9
    v_and_b32 v214, v218, v10
    v_and_b32 v215, v218, v11
    s_nop 1
    v_mfma_f32_16x16x32_bf16 v[232:235], v[212:215], v[168:171], v[232:235]
    v_and_b32 v212, v222, v8
    v_and_b32 v213, v222, v9
    v_and_b32 v214, v222, v10
    v_and_b32 v215, v222, v11
    s_nop 1
    v_mfma_f32_16x16x32_bf16 v[236:239], v[212:215], v[168:171], v[236:239]
    v_and_b32 v212, v226, v8
    v_and_b32 v213, v226, v9
    v_and_b32 v214, v226, v10
    v_and_b32 v215, v226, v11
    s_nop 1
    v_mfma_f32_16x16x32_bf16 v[240:243], v[212:215], v[168:171], v[240:243]
    v_and_b32 v212, v230, v8
    v_and_b32 v213, v230, v9
    v_and_b32 v214, v230, v10
    v_and_b32 v215, v230, v11
    s_nop 1
    v_mfma_f32_16x16x32_bf16 v[244:247], v[212:215], v[168:171], v[244:247]
    v_and_b32 v212, v219, v8
    v_and_b32 v213, v219, v9
    v_and_b32 v214, v219, v10
    v_and_b32 v215, v219, v11
    s_nop 1
    v_mfma_f32_16x16x32_bf16 v[232:235], v[212:215], v[188:191], v[232:235]
    v_and_b32 v212, v223, v8
    v_and_b32 v213, v223, v9
    v_and_b32 v214, v223, v10
    v_and_b32 v215, v223, v11
    s_nop 1
    v_mfma_f32_16x16x32_bf16 v[236:239], v[212:215], v[188:191], v[236:239]
    v_and_b32 v212, v227, v8
    v_and_b32 v213, v227, v9
    v_and_b32 v214, v227, v10
    v_and_b32 v215, v227, v11
    s_nop 1
    v_mfma_f32_16x16x32_bf16 v[240:243], v[212:215], v[188:191], v[240:243]
    v_and_b32 v212, v231, v8
    v_and_b32 v213, v231, v9
    v_and_b32 v214, v231, v10
    v_and_b32 v215, v231, v11
    s_nop 1
    v_mfma_f32_16x16x32_bf16 v[244:247], v[212:215], v[188:191], v[244:247]
    s_nop 7
    s_nop 1
    ds_write_b128 v210, v[232:235] offset:0
    ds_write_b128 v210, v[236:239] offset:5120
    ds_write_b128 v210, v[240:243] offset:10240
    ds_write_b128 v210, v[244:247] offset:15360
    s_nop 3
    v_and_b32 v212, v216, v8
    v_and_b32 v213, v216, v9
    v_and_b32 v214, v216, v10
    v_and_b32 v215, v216, v11
    s_nop 1
    v_mfma_f32_16x16x32_bf16 v[232:235], v[212:215], v[132:135], 0
    v_and_b32 v212, v220, v8
    v_and_b32 v213, v220, v9
    v_and_b32 v214, v220, v10
    v_and_b32 v215, v220, v11
    s_nop 1
    v_mfma_f32_16x16x32_bf16 v[236:239], v[212:215], v[132:135], 0
    v_and_b32 v212, v224, v8
    v_and_b32 v213, v224, v9
    v_and_b32 v214, v224, v10
    v_and_b32 v215, v224, v11
    s_nop 1
    v_mfma_f32_16x16x32_bf16 v[240:243], v[212:215], v[132:135], 0
    v_and_b32 v212, v228, v8
    v_and_b32 v213, v228, v9
    v_and_b32 v214, v228, v10
    v_and_b32 v215, v228, v11
    s_nop 1
    v_mfma_f32_16x16x32_bf16 v[244:247], v[212:215], v[132:135], 0
    v_and_b32 v212, v217, v8
    v_and_b32 v213, v217, v9
    v_and_b32 v214, v217, v10
    v_and_b32 v215, v217, v11
    s_nop 1
    v_mfma_f32_16x16x32_bf16 v[232:235], v[212:215], v[152:155], v[232:235]
    v_and_b32 v212, v221, v8
    v_and_b32 v213, v221, v9
    v_and_b32 v214, v221, v10
    v_and_b32 v215, v221, v11
    s_nop 1
    v_mfma_f32_16x16x32_bf16 v[236:239], v[212:215], v[152:155], v[236:239]
    v_and_b32 v212, v225, v8
    v_and_b32 v213, v225, v9
    v_and_b32 v214, v225, v10
    v_and_b32 v215, v225, v11
    s_nop 1
    v_mfma_f32_16x16x32_bf16 v[240:243], v[212:215], v[152:155], v[240:243]
    v_and_b32 v212, v229, v8
    v_and_b32 v213, v229, v9
    v_and_b32 v214, v229, v10
    v_and_b32 v215, v229, v11
    s_nop 1
    v_mfma_f32_16x16x32_bf16 v[244:247], v[212:215], v[152:155], v[244:247]
    v_and_b32 v212, v218, v8
    v_and_b32 v213, v218, v9
    v_and_b32 v214, v218, v10
    v_and_b32 v215, v218, v11
    s_nop 1
    v_mfma_f32_16x16x32_bf16 v[232:235], v[212:215], v[172:175], v[232:235]
    v_and_b32 v212, v222, v8
    v_and_b32 v213, v222, v9
    v_and_b32 v214, v222, v10
    v_and_b32 v215, v222, v11
    s_nop 1
    v_mfma_f32_16x16x32_bf16 v[236:239], v[212:215], v[172:175], v[236:239]
    v_and_b32 v212, v226, v8
    v_and_b32 v213, v226, v9
    v_and_b32 v214, v226, v10
    v_and_b32 v215, v226, v11
    s_nop 1
    v_mfma_f32_16x16x32_bf16 v[240:243], v[212:215], v[172:175], v[240:243]
    v_and_b32 v212, v230, v8
    v_and_b32 v213, v230, v9
    v_and_b32 v214, v230, v10
    v_and_b32 v215, v230, v11
    s_nop 1
    v_mfma_f32_16x16x32_bf16 v[244:247], v[212:215], v[172:175], v[244:247]
    v_and_b32 v212, v219, v8
    v_and_b32 v213, v219, v9
    v_and_b32 v214, v219, v10
    v_and_b32 v215, v219, v11
    s_nop 1
    v_mfma_f32_16x16x32_bf16 v[232:235], v[212:215], v[192:195], v[232:235]
    v_and_b32 v212, v223, v8
    v_and_b32 v213, v223, v9
    v_and_b32 v214, v223, v10
    v_and_b32 v215, v223, v11
    s_nop 1
    v_mfma_f32_16x16x32_bf16 v[236:239], v[212:215], v[192:195], v[236:239]
    v_and_b32 v212, v227, v8
    v_and_b32 v213, v227, v9
    v_and_b32 v214, v227, v10
    v_and_b32 v215, v227, v11
    s_nop 1
    v_mfma_f32_16x16x32_bf16 v[240:243], v[212:215], v[192:195], v[240:243]
    v_and_b32 v212, v231, v8
    v_and_b32 v213, v231, v9
    v_and_b32 v214, v231, v10
    v_and_b32 v215, v231, v11
    s_nop 1
    v_mfma_f32_16x16x32_bf16 v[244:247], v[212:215], v[192:195], v[244:247]
    s_nop 7
    s_nop 1
    ds_write_b128 v210, v[232:235] offset:512
    ds_write_b128 v210, v[236:239] offset:5632
    ds_write_b128 v210, v[240:243] offset:10752
    ds_write_b128 v210, v[244:247] offset:15872
    s_nop 3
    v_and_b32 v212, v216, v8
    v_and_b32 v213, v216, v9
    v_and_b32 v214, v216, v10
    v_and_b32 v215, v216, v11
    s_nop 1
    v_mfma_f32_16x16x32_bf16 v[232:235], v[212:215], v[136:139], 0
    v_and_b32 v212, v220, v8
    v_and_b32 v213, v220, v9
    v_and_b32 v214, v220, v10
    v_and_b32 v215, v220, v11
    s_nop 1
    v_mfma_f32_16x16x32_bf16 v[236:239], v[212:215], v[136:139], 0
    v_and_b32 v212, v224, v8
    v_and_b32 v213, v224, v9
    v_and_b32 v214, v224, v10
    v_and_b32 v215, v224, v11
    s_nop 1
    v_mfma_f32_16x16x32_bf16 v[240:243], v[212:215], v[136:139], 0
    v_and_b32 v212, v228, v8
    v_and_b32 v213, v228, v9
    v_and_b32 v214, v228, v10
    v_and_b32 v215, v228, v11
    s_nop 1
    v_mfma_f32_16x16x32_bf16 v[244:247], v[212:215], v[136:139], 0
    v_and_b32 v212, v217, v8
    v_and_b32 v213, v217, v9
    v_and_b32 v214, v217, v10
    v_and_b32 v215, v217, v11
    s_nop 1
    v_mfma_f32_16x16x32_bf16 v[232:235], v[212:215], v[156:159], v[232:235]
    v_and_b32 v212, v221, v8
    v_and_b32 v213, v221, v9
    v_and_b32 v214, v221, v10
    v_and_b32 v215, v221, v11
    s_nop 1
    v_mfma_f32_16x16x32_bf16 v[236:239], v[212:215], v[156:159], v[236:239]
    v_and_b32 v212, v225, v8
    v_and_b32 v213, v225, v9
    v_and_b32 v214, v225, v10
    v_and_b32 v215, v225, v11
    s_nop 1
    v_mfma_f32_16x16x32_bf16 v[240:243], v[212:215], v[156:159], v[240:243]
    v_and_b32 v212, v229, v8
    v_and_b32 v213, v229, v9
    v_and_b32 v214, v229, v10
    v_and_b32 v215, v229, v11
    s_nop 1
    v_mfma_f32_16x16x32_bf16 v[244:247], v[212:215], v[156:159], v[244:247]
    v_and_b32 v212, v218, v8
    v_and_b32 v213, v218, v9
    v_and_b32 v214, v218, v10
    v_and_b32 v215, v218, v11
    s_nop 1
    v_mfma_f32_16x16x32_bf16 v[232:235], v[212:215], v[176:179], v[232:235]
    v_and_b32 v212, v222, v8
    v_and_b32 v213, v222, v9
    v_and_b32 v214, v222, v10
    v_and_b32 v215, v222, v11
    s_nop 1
    v_mfma_f32_16x16x32_bf16 v[236:239], v[212:215], v[176:179], v[236:239]
    v_and_b32 v212, v226, v8
    v_and_b32 v213, v226, v9
    v_and_b32 v214, v226, v10
    v_and_b32 v215, v226, v11
    s_nop 1
    v_mfma_f32_16x16x32_bf16 v[240:243], v[212:215], v[176:179], v[240:243]
    v_and_b32 v212, v230, v8
    v_and_b32 v213, v230, v9
    v_and_b32 v214, v230, v10
    v_and_b32 v215, v230, v11
    s_nop 1
    v_mfma_f32_16x16x32_bf16 v[244:247], v[212:215], v[176:179], v[244:247]
    v_and_b32 v212, v219, v8
    v_and_b32 v213, v219, v9
    v_and_b32 v214, v219, v10
    v_and_b32 v215, v219, v11
    s_nop 1
    v_mfma_f32_16x16x32_bf16 v[232:235], v[212:215], v[196:199], v[232:235]
    v_and_b32 v212, v223, v8
    v_and_b32 v213, v223, v9
    v_and_b32 v214, v223, v10
    v_and_b32 v215, v223, v11
    s_nop 1
    v_mfma_f32_16x16x32_bf16 v[236:239], v[212:215], v[196:199], v[236:239]
    v_and_b32 v212, v227, v8
    v_and_b32 v213, v227, v9
    v_and_b32 v214, v227, v10
    v_and_b32 v215, v227, v11
    s_nop 1
    v_mfma_f32_16x16x32_bf16 v[240:243], v[212:215], v[196:199], v[240:243]
    v_and_b32 v212, v231, v8
    v_and_b32 v213, v231, v9
    v_and_b32 v214, v231, v10
    v_and_b32 v215, v231, v11
    s_nop 1
    v_mfma_f32_16x16x32_bf16 v[244:247], v[212:215], v[196:199], v[244:247]
    s_nop 7
    s_nop 1
    ds_write_b128 v210, v[232:235] offset:1024
    ds_write_b128 v210, v[236:239] offset:6144
    ds_write_b128 v210, v[240:243] offset:11264
    ds_write_b128 v210, v[244:247] offset:16384
    s_nop 3
    v_and_b32 v212, v216, v8
    v_and_b32 v213, v216, v9
    v_and_b32 v214, v216, v10
    v_and_b32 v215, v216, v11
    s_nop 1
    v_mfma_f32_16x16x32_bf16 v[232:235], v[212:215], v[140:143], 0
    v_and_b32 v212, v220, v8
    v_and_b32 v213, v220, v9
    v_and_b32 v214, v220, v10
    v_and_b32 v215, v220, v11
    s_nop 1
    v_mfma_f32_16x16x32_bf16 v[236:239], v[212:215], v[140:143], 0
    v_and_b32 v212, v224, v8
    v_and_b32 v213, v224, v9
    v_and_b32 v214, v224, v10
    v_and_b32 v215, v224, v11
    s_nop 1
    v_mfma_f32_16x16x32_bf16 v[240:243], v[212:215], v[140:143], 0
    v_and_b32 v212, v228, v8
    v_and_b32 v213, v228, v9
    v_and_b32 v214, v228, v10
    v_and_b32 v215, v228, v11
    s_nop 1
    v_mfma_f32_16x16x32_bf16 v[244:247], v[212:215], v[140:143], 0
    v_and_b32 v212, v217, v8
    v_and_b32 v213, v217, v9
    v_and_b32 v214, v217, v10
    v_and_b32 v215, v217, v11
    s_nop 1
    v_mfma_f32_16x16x32_bf16 v[232:235], v[212:215], v[160:163], v[232:235]
    v_and_b32 v212, v221, v8
    v_and_b32 v213, v221, v9
    v_and_b32 v214, v221, v10
    v_and_b32 v215, v221, v11
    s_nop 1
    v_mfma_f32_16x16x32_bf16 v[236:239], v[212:215], v[160:163], v[236:239]
    v_and_b32 v212, v225, v8
    v_and_b32 v213, v225, v9
    v_and_b32 v214, v225, v10
    v_and_b32 v215, v225, v11
    s_nop 1
    v_mfma_f32_16x16x32_bf16 v[240:243], v[212:215], v[160:163], v[240:243]
    v_and_b32 v212, v229, v8
    v_and_b32 v213, v229, v9
    v_and_b32 v214, v229, v10
    v_and_b32 v215, v229, v11
    s_nop 1
    v_mfma_f32_16x16x32_bf16 v[244:247], v[212:215], v[160:163], v[244:247]
    v_and_b32 v212, v218, v8
    v_and_b32 v213, v218, v9
    v_and_b32 v214, v218, v10
    v_and_b32 v215, v218, v11
    s_nop 1
    v_mfma_f32_16x16x32_bf16 v[232:235], v[212:215], v[180:183], v[232:235]
    v_and_b32 v212, v222, v8
    v_and_b32 v213, v222, v9
    v_and_b32 v214, v222, v10
    v_and_b32 v215, v222, v11
    s_nop 1
    v_mfma_f32_16x16x32_bf16 v[236:239], v[212:215], v[180:183], v[236:239]
    v_and_b32 v212, v226, v8
    v_and_b32 v213, v226, v9
    v_and_b32 v214, v226, v10
    v_and_b32 v215, v226, v11
    s_nop 1
    v_mfma_f32_16x16x32_bf16 v[240:243], v[212:215], v[180:183], v[240:243]
    v_and_b32 v212, v230, v8
    v_and_b32 v213, v230, v9
    v_and_b32 v214, v230, v10
    v_and_b32 v215, v230, v11
    s_nop 1
    v_mfma_f32_16x16x32_bf16 v[244:247], v[212:215], v[180:183], v[244:247]
    v_and_b32 v212, v219, v8
    v_and_b32 v213, v219, v9
    v_and_b32 v214, v219, v10
    v_and_b32 v215, v219, v11
    s_nop 1
    v_mfma_f32_16x16x32_bf16 v[232:235], v[212:215], v[200:203], v[232:235]
    v_and_b32 v212, v223, v8
    v_and_b32 v213, v223, v9
    v_and_b32 v214, v223, v10
    v_and_b32 v215, v223, v11
    s_nop 1
    v_mfma_f32_16x16x32_bf16 v[236:239], v[212:215], v[200:203], v[236:239]
    v_and_b32 v212, v227, v8
    v_and_b32 v213, v227, v9
    v_and_b32 v214, v227, v10
    v_and_b32 v215, v227, v11
    s_nop 1
    v_mfma_f32_16x16x32_bf16 v[240:243], v[212:215], v[200:203], v[240:243]
    v_and_b32 v212, v231, v8
    v_and_b32 v213, v231, v9
    v_and_b32 v214, v231, v10
    v_and_b32 v215, v231, v11
    s_nop 1
    v_mfma_f32_16x16x32_bf16 v[244:247], v[212:215], v[200:203], v[244:247]
    s_nop 7
    s_nop 1
    ds_write_b128 v210, v[232:235] offset:1536
    ds_write_b128 v210, v[236:239] offset:6656
    ds_write_b128 v210, v[240:243] offset:11776
    ds_write_b128 v210, v[244:247] offset:16896
    s_nop 3
    v_and_b32 v212, v216, v8
    v_and_b32 v213, v216, v9
    v_and_b32 v214, v216, v10
    v_and_b32 v215, v216, v11
    s_nop 1
    v_mfma_f32_16x16x32_bf16 v[232:235], v[212:215], v[144:147], 0
    v_and_b32 v212, v220, v8
    v_and_b32 v213, v220, v9
    v_and_b32 v214, v220, v10
    v_and_b32 v215, v220, v11
    s_nop 1
    v_mfma_f32_16x16x32_bf16 v[236:239], v[212:215], v[144:147], 0
    v_and_b32 v212, v224, v8
    v_and_b32 v213, v224, v9
    v_and_b32 v214, v224, v10
    v_and_b32 v215, v224, v11
    s_nop 1
    v_mfma_f32_16x16x32_bf16 v[240:243], v[212:215], v[144:147], 0
    v_and_b32 v212, v228, v8
    v_and_b32 v213, v228, v9
    v_and_b32 v214, v228, v10
    v_and_b32 v215, v228, v11
    s_nop 1
    v_mfma_f32_16x16x32_bf16 v[244:247], v[212:215], v[144:147], 0
    v_and_b32 v212, v217, v8
    v_and_b32 v213, v217, v9
    v_and_b32 v214, v217, v10
    v_and_b32 v215, v217, v11
    s_nop 1
    v_mfma_f32_16x16x32_bf16 v[232:235], v[212:215], v[164:167], v[232:235]
    v_and_b32 v212, v221, v8
    v_and_b32 v213, v221, v9
    v_and_b32 v214, v221, v10
    v_and_b32 v215, v221, v11
    s_nop 1
    v_mfma_f32_16x16x32_bf16 v[236:239], v[212:215], v[164:167], v[236:239]
    v_and_b32 v212, v225, v8
    v_and_b32 v213, v225, v9
    v_and_b32 v214, v225, v10
    v_and_b32 v215, v225, v11
    s_nop 1
    v_mfma_f32_16x16x32_bf16 v[240:243], v[212:215], v[164:167], v[240:243]
    v_and_b32 v212, v229, v8
    v_and_b32 v213, v229, v9
    v_and_b32 v214, v229, v10
    v_and_b32 v215, v229, v11
    s_nop 1
    v_mfma_f32_16x16x32_bf16 v[244:247], v[212:215], v[164:167], v[244:247]
    v_and_b32 v212, v218, v8
    v_and_b32 v213, v218, v9
    v_and_b32 v214, v218, v10
    v_and_b32 v215, v218, v11
    s_nop 1
    v_mfma_f32_16x16x32_bf16 v[232:235], v[212:215], v[184:187], v[232:235]
    v_and_b32 v212, v222, v8
    v_and_b32 v213, v222, v9
    v_and_b32 v214, v222, v10
    v_and_b32 v215, v222, v11
    s_nop 1
    v_mfma_f32_16x16x32_bf16 v[236:239], v[212:215], v[184:187], v[236:239]
    v_and_b32 v212, v226, v8
    v_and_b32 v213, v226, v9
    v_and_b32 v214, v226, v10
    v_and_b32 v215, v226, v11
    s_nop 1
    v_mfma_f32_16x16x32_bf16 v[240:243], v[212:215], v[184:187], v[240:243]
    v_and_b32 v212, v230, v8
    v_and_b32 v213, v230, v9
    v_and_b32 v214, v230, v10
    v_and_b32 v215, v230, v11
    s_nop 1
    v_mfma_f32_16x16x32_bf16 v[244:247], v[212:215], v[184:187], v[244:247]
    v_and_b32 v212, v219, v8
    v_and_b32 v213, v219, v9
    v_and_b32 v214, v219, v10
    v_and_b32 v215, v219, v11
    s_nop 1
    v_mfma_f32_16x16x32_bf16 v[232:235], v[212:215], v[204:207], v[232:235]
    v_and_b32 v212, v223, v8
    v_and_b32 v213, v223, v9
    v_and_b32 v214, v223, v10
    v_and_b32 v215, v223, v11
    s_nop 1
    v_mfma_f32_16x16x32_bf16 v[236:239], v[212:215], v[204:207], v[236:239]
    v_and_b32 v212, v227, v8
    v_and_b32 v213, v227, v9
    v_and_b32 v214, v227, v10
    v_and_b32 v215, v227, v11
    s_nop 1
    v_mfma_f32_16x16x32_bf16 v[240:243], v[212:215], v[204:207], v[240:243]
    v_and_b32 v212, v231, v8
    v_and_b32 v213, v231, v9
    v_and_b32 v214, v231, v10
    v_and_b32 v215, v231, v11
    s_nop 1
    v_mfma_f32_16x16x32_bf16 v[244:247], v[212:215], v[204:207], v[244:247]
    s_nop 7
    s_nop 1
    ds_write_b128 v210, v[232:235] offset:2048
    ds_write_b128 v210, v[236:239] offset:7168
    ds_write_b128 v210, v[240:243] offset:12288
    ds_write_b128 v210, v[244:247] offset:17408
    s_nop 3
    s_waitcnt lgkmcnt(0)
    s_setprio 0
L_loop:
    s_mov_b64 exec, 1
    v_mov_b32 v122, 39232
    v_mov_b32 v123, 1
    ds_add_rtn_u32 v124, v122, v123
    s_mov_b64 exec, -1
    s_waitcnt vmcnt(8)
    v_mfma_f32_16x16x32_bf16 v[96:99], v[32:35], v[16:19], 0
    v_mfma_f32_16x16x32_bf16 v[100:103], v[48:51], v[16:19], 0
    v_mfma_f32_16x16x32_bf16 v[96:99], v[36:39], v[20:23], v[96:99]
    v_mfma_f32_16x16x32_bf16 v[100:103], v[52:55], v[20:23], v[100:103]
    v_mfma_f32_16x16x32_bf16 v[96:99], v[40:43], v[24:27], v[96:99]
    v_mfma_f32_16x16x32_bf16 v[100:103], v[56:59], v[24:27], v[100:103]
    v_mfma_f32_16x16x32_bf16 v[96:99], v[44:47], v[28:31], v[96:99]
    v_mfma_f32_16x16x32_bf16 v[100:103], v[60:63], v[28:31], v[100:103]
    s_waitcnt lgkmcnt(0)
    v_readfirstlane_b32 s81, v124
    s_nop 3
    s_cmp_ge_u32 s81, 128
    s_cbranch_scc1 L_last
    s_cmp_ge_u32 s81, s82
    s_cbranch_scc0 L_nowo
    s_mov_b32 s82, 1000
    buffer_load_dwordx4 v[128:131], v126, s[44:47], s76 offen offset:0
    buffer_load_dwordx4 v[132:135], v126, s[44:47], s76 offen offset:256
    buffer_load_dwordx4 v[136:139], v126, s[44:47], s76 offen offset:512
    buffer_load_dwordx4 v[140:143], v126, s[44:47], s76 offen offset:768
    buffer_load_dwordx4 v[144:147], v126, s[44:47], s76 offen offset:1024
    buffer_load_dwordx4 v[148:151], v126, s[44:47], s76 offen offset:1280
    buffer_load_dwordx4 v[152:155], v126, s[44:47], s76 offen offset:1536
    buffer_load_dwordx4 v[156:159], v126, s[44:47], s76 offen offset:1792
    buffer_load_dwordx4 v[160:163], v126, s[44:47], s76 offen offset:2048
    buffer_load_dwordx4 v[164:167], v126, s[44:47], s76 offen offset:2304
    buffer_load_dwordx4 v[168:171], v127, s[44:47], s76 offen offset:0
    buffer_load_dwordx4 v[172:175], v127, s[44:47], s76 offen offset:256
    buffer_load_dwordx4 v[176:179], v127, s[44:47], s76 offen offset:512
    buffer_load_dwordx4 v[180:183], v127, s[44:47], s76 offen offset:768
    buffer_load_dwordx4 v[184:187], v127, s[44:47], s76 offen offset:1024
    buffer_load_dwordx4 v[188:191], v127, s[44:47], s76 offen offset:1280
    buffer_load_dwordx4 v[192:195], v127, s[44:47], s76 offen offset:1536
    buffer_load_dwordx4 v[196:199], v127, s[44:47], s76 offen offset:1792
    buffer_load_dwordx4 v[200:203], v127, s[44:47], s76 offen offset:2048
    buffer_load_dwordx4 v[204:207], v127, s[44:47], s76 offen offset:2304
L_nowo:
    s_lshl_b32 s78, s81, 13
    buffer_load_dwordx4 v[32:35], v6, s[32:35], s78 offen offset:0 sc1 nt
    buffer_load_dwordx4 v[36:39], v6, s[32:35], s78 offen offset:64 sc1 nt
    buffer_load_dwordx4 v[40:43], v6, s[32:35], s78 offen offset:128 sc1 nt
    buffer_load_dwordx4 v[44:47], v6, s[32:35], s78 offen offset:192 sc1 nt
    buffer_load_dwordx4 v[48:51], v7, s[32:35], s78 offen offset:0 sc1 nt
    buffer_load_dwordx4 v[52:55], v7, s[32:35], s78 offen offset:64 sc1 nt
    buffer_load_dwordx4 v[56:59], v7, s[32:35], s78 offen offset:128 sc1 nt
    buffer_load_dwordx4 v[60:63], v7, s[32:35], s78 offen offset:192 sc1 nt
    v_max3_f32 v122, v96, v97, v98
    v_max3_f32 v123, v99, v100, v101
    v_max3_f32 v122, v102, v103, v122
    v_max_f32 v122, v122, v123
    v_mov_b32 v123, v122
    s_nop 1
    v_permlane16_swap_b32 v122, v123
    s_nop 0
    v_max_f32 v122, v122, v123
    v_mov_b32 v123, v122
    s_nop 1
    v_permlane32_swap_b32 v122, v123
    s_nop 0
    v_max_f32 v122, v122, v123
    v_mul_f32 v122, s77, v122
    v_max_f32 v122, v120, v122
    v_sub_f32 v123, v120, v122
    v_exp_f32 v123, v123
    v_mov_b32 v120, v122
    v_fma_f32 v96, v96, s77, -v122
    v_fma_f32 v97, v97, s77, -v122
    v_fma_f32 v98, v98, s77, -v122
    v_fma_f32 v99, v99, s77, -v122
    v_fma_f32 v100, v100, s77, -v122
    v_fma_f32 v101, v101, s77, -v122
    v_fma_f32 v102, v102, s77, -v122
    v_fma_f32 v103, v103, s77, -v122
    v_exp_f32 v96, v96
    v_exp_f32 v97, v97
    v_exp_f32 v98, v98
    v_exp_f32 v99, v99
    v_exp_f32 v100, v100
    v_exp_f32 v101, v101
    v_exp_f32 v102, v102
    v_exp_f32 v103, v103
    v_mul_f32 v121, v121, v123
    v_mul_f32 v12, v12, v123
    v_mul_f32 v13, v13, v123
    v_mul_f32 v14, v14, v123
    v_mul_f32 v15, v15, v123
    v_add_f32 v124, v96, v97
    v_add_f32 v125, v98, v99
    v_add_f32 v124, v124, v100
    v_add_f32 v125, v125, v101
    v_add_f32 v124, v124, v102
    v_add_f32 v125, v125, v103
    v_add_f32 v121, v121, v124
    v_add_f32 v121, v121, v125
    v_cvt_pk_bf16_f32 v96, v96, v96
    v_cvt_pk_bf16_f32 v97, v97, v97
    v_cvt_pk_bf16_f32 v98, v98, v98
    v_cvt_pk_bf16_f32 v99, v99, v99
    v_cvt_pk_bf16_f32 v100, v100, v100
    v_cvt_pk_bf16_f32 v101, v101, v101
    v_cvt_pk_bf16_f32 v102, v102, v102
    v_cvt_pk_bf16_f32 v103, v103, v103
    v_and_b32 v104, v96, v8
    v_and_b32 v105, v96, v9
    v_and_b32 v106, v96, v10
    v_and_b32 v107, v96, v11
    v_and_b32 v108, v97, v8
    v_and_b32 v109, v97, v9
    v_and_b32 v110, v97, v10
    v_and_b32 v111, v97, v11
    s_waitcnt vmcnt(8)
    v_and_b32 v112, v98, v8
    v_and_b32 v113, v98, v9
    v_and_b32 v114, v98, v10
    v_and_b32 v115, v98, v11
    v_mfma_f32_16x16x32_bf16 v[12:15], v[104:107], v[64:67], v[12:15]
    v_and_b32 v116, v99, v8
    v_and_b32 v117, v99, v9
    v_and_b32 v118, v99, v10
    v_and_b32 v119, v99, v11
    v_mfma_f32_16x16x32_bf16 v[12:15], v[108:111], v[68:71], v[12:15]
    v_and_b32 v104, v100, v8
    v_and_b32 v105, v100, v9
    v_and_b32 v106, v100, v10
    v_and_b32 v107, v100, v11
    v_mfma_f32_16x16x32_bf16 v[12:15], v[112:115], v[72:75], v[12:15]
    v_and_b32 v108, v101, v8
    v_and_b32 v109, v101, v9
    v_and_b32 v110, v101, v10
    v_and_b32 v111, v101, v11
    v_mfma_f32_16x16x32_bf16 v[12:15], v[116:119], v[76:79], v[12:15]
    v_and_b32 v112, v102, v8
    v_and_b32 v113, v102, v9
    v_and_b32 v114, v102, v10
    v_and_b32 v115, v102, v11
    v_mfma_f32_16x16x32_bf16 v[12:15], v[104:107], v[80:83], v[12:15]
    v_and_b32 v116, v103, v8
    v_and_b32 v117, v103, v9
    v_and_b32 v118, v103, v10
    v_and_b32 v119, v103, v11
    v_mfma_f32_16x16x32_bf16 v[12:15], v[108:111], v[84:87], v[12:15]
    s_nop 1
    v_mfma_f32_16x16x32_bf16 v[12:15], v[112:115], v[88:91], v[12:15]
    s_nop 1
    v_mfma_f32_16x16x32_bf16 v[12:15], v[116:119], v[92:95], v[12:15]
    buffer_load_dwordx4 v[64:67], v4, s[36:39], s78 offen offset:0 sc1 nt
    buffer_load_dwordx4 v[68:71], v4, s[36:39], s78 offen offset:1024 sc1 nt
    buffer_load_dwordx4 v[72:75], v4, s[36:39], s78 offen offset:2048 sc1 nt
    buffer_load_dwordx4 v[76:79], v4, s[36:39], s78 offen offset:3072 sc1 nt
    buffer_load_dwordx4 v[80:83], v5, s[36:39], s78 offen offset:0 sc1 nt
    buffer_load_dwordx4 v[84:87], v5, s[36:39], s78 offen offset:1024 sc1 nt
    buffer_load_dwordx4 v[88:91], v5, s[36:39], s78 offen offset:2048 sc1 nt
    buffer_load_dwordx4 v[92:95], v5, s[36:39], s78 offen offset:3072 sc1 nt
    s_branch L_loop
L_last:
    s_cmp_ge_u32 s82, 1000
    s_cbranch_scc1 L_last2
    s_waitcnt vmcnt(0)
    buffer_load_dwordx4 v[128:131], v126, s[44:47], s76 offen offset:0
    buffer_load_dwordx4 v[132:135], v126, s[44:47], s76 offen offset:256
    buffer_load_dwordx4 v[136:139], v126, s[44:47], s76 offen offset:512
    buffer_load_dwordx4 v[140:143], v126, s[44:47], s76 offen offset:768
    buffer_load_dwordx4 v[144:147], v126, s[44:47], s76 offen offset:1024
    buffer_load_dwordx4 v[148:151], v126, s[44:47], s76 offen offset:1280
    buffer_load_dwordx4 v[152:155], v126, s[44:47], s76 offen offset:1536
    buffer_load_dwordx4 v[156:159], v126, s[44:47], s76 offen offset:1792
    buffer_load_dwordx4 v[160:163], v126, s[44:47], s76 offen offset:2048
    buffer_load_dwordx4 v[164:167], v126, s[44:47], s76 offen offset:2304
    buffer_load_dwordx4 v[168:171], v127, s[44:47], s76 offen offset:0
    buffer_load_dwordx4 v[172:175], v127, s[44:47], s76 offen offset:256
    buffer_load_dwordx4 v[176:179], v127, s[44:47], s76 offen offset:512
    buffer_load_dwordx4 v[180:183], v127, s[44:47], s76 offen offset:768
    buffer_load_dwordx4 v[184:187], v127, s[44:47], s76 offen offset:1024
    buffer_load_dwordx4 v[188:191], v127, s[44:47], s76 offen offset:1280
    buffer_load_dwordx4 v[192:195], v127, s[44:47], s76 offen offset:1536
    buffer_load_dwordx4 v[196:199], v127, s[44:47], s76 offen offset:1792
    buffer_load_dwordx4 v[200:203], v127, s[44:47], s76 offen offset:2048
    buffer_load_dwordx4 v[204:207], v127, s[44:47], s76 offen offset:2304
    s_branch L_last3
L_last2:
    s_nop 7
    s_waitcnt vmcnt(0)
L_last3:
    v_max3_f32 v122, v96, v97, v98
    v_max3_f32 v123, v99, v100, v101
    v_max3_f32 v122, v102, v103, v122
    v_max_f32 v122, v122, v123
    v_mov_b32 v123, v122
    s_nop 1
    v_permlane16_swap_b32 v122, v123
    s_nop 0
    v_max_f32 v122, v122, v123
    v_mov_b32 v123, v122
    s_nop 1
    v_permlane32_swap_b32 v122, v123
    s_nop 0
    v_max_f32 v122, v122, v123
    v_mul_f32 v122, s77, v122
    v_max_f32 v122, v120, v122
    v_sub_f32 v123, v120, v122
    v_exp_f32 v123, v123
    v_mov_b32 v120, v122
    v_fma_f32 v96, v96, s77, -v122
    v_fma_f32 v97, v97, s77, -v122
    v_fma_f32 v98, v98, s77, -v122
    v_fma_f32 v99, v99, s77, -v122
    v_fma_f32 v100, v100, s77, -v122
    v_fma_f32 v101, v101, s77, -v122
    v_fma_f32 v102, v102, s77, -v122
    v_fma_f32 v103, v103, s77, -v122
    v_exp_f32 v96, v96
    v_exp_f32 v97, v97
    v_exp_f32 v98, v98
    v_exp_f32 v99, v99
    v_exp_f32 v100, v100
    v_exp_f32 v101, v101
    v_exp_f32 v102, v102
    v_exp_f32 v103, v103
    v_mul_f32 v121, v121, v123
    v_mul_f32 v12, v12, v123
    v_mul_f32 v13, v13, v123
    v_mul_f32 v14, v14, v123
    v_mul_f32 v15, v15, v123
    v_add_f32 v124, v96, v97
    v_add_f32 v125, v98, v99
    v_add_f32 v124, v124, v100
    v_add_f32 v125, v125, v101
    v_add_f32 v124, v124, v102
    v_add_f32 v125, v125, v103
    v_add_f32 v121, v121, v124
    v_add_f32 v121, v121, v125
    v_cvt_pk_bf16_f32 v96, v96, v96
    v_cvt_pk_bf16_f32 v97, v97, v97
    v_cvt_pk_bf16_f32 v98, v98, v98
    v_cvt_pk_bf16_f32 v99, v99, v99
    v_cvt_pk_bf16_f32 v100, v100, v100
    v_cvt_pk_bf16_f32 v101, v101, v101
    v_cvt_pk_bf16_f32 v102, v102, v102
    v_cvt_pk_bf16_f32 v103, v103, v103
    v_and_b32 v104, v96, v8
    v_and_b32 v105, v96, v9
    v_and_b32 v106, v96, v10
    v_and_b32 v107, v96, v11
    v_and_b32 v108, v97, v8
    v_and_b32 v109, v97, v9
    v_and_b32 v110, v97, v10
    v_and_b32 v111, v97, v11
    v_and_b32 v112, v98, v8
    v_and_b32 v113, v98, v9
    v_and_b32 v114, v98, v10
    v_and_b32 v115, v98, v11
    v_mfma_f32_16x16x32_bf16 v[12:15], v[104:107], v[64:67], v[12:15]
    v_and_b32 v116, v99, v8
    v_and_b32 v117, v99, v9
    v_and_b32 v118, v99, v10
    v_and_b32 v119, v99, v11
    v_mfma_f32_16x16x32_bf16 v[12:15], v[108:111], v[68:71], v[12:15]
    v_and_b32 v104, v100, v8
    v_and_b32 v105, v100, v9
    v_and_b32 v106, v100, v10
    v_and_b32 v107, v100, v11
    v_mfma_f32_16x16x32_bf16 v[12:15], v[112:115], v[72:75], v[12:15]
    v_and_b32 v108, v101, v8
    v_and_b32 v109, v101, v9
    v_and_b32 v110, v101, v10
    v_and_b32 v111, v101, v11
    v_mfma_f32_16x16x32_bf16 v[12:15], v[116:119], v[76:79], v[12:15]
    v_and_b32 v112, v102, v8
    v_and_b32 v113, v102, v9
    v_and_b32 v114, v102, v10
    v_and_b32 v115, v102, v11
    v_mfma_f32_16x16x32_bf16 v[12:15], v[104:107], v[80:83], v[12:15]
    v_and_b32 v116, v103, v8
    v_and_b32 v117, v103, v9
    v_and_b32 v118, v103, v10
    v_and_b32 v119, v103, v11
    v_mfma_f32_16x16x32_bf16 v[12:15], v[108:111], v[84:87], v[12:15]
    s_nop 1
    v_mfma_f32_16x16x32_bf16 v[12:15], v[112:115], v[88:91], v[12:15]
    s_nop 1
    v_mfma_f32_16x16x32_bf16 v[12:15], v[116:119], v[92:95], v[12:15]
    v_mov_b32 v122, v121
    s_nop 1
    v_permlane16_swap_b32 v121, v122
    s_nop 0
    v_add_f32 v121, v121, v122
    v_mov_b32 v122, v121
    s_nop 1
    v_permlane32_swap_b32 v121, v122
    s_nop 0
    v_add_f32 v121, v121, v122
    v_and_b32 v122, 1, v3
    v_lshlrev_b32 v122, 4, v122
    v_lshl_add_u32 v122, v2, 5, v122
    s_lshl_b32 s75, s72, 9
    v_add_u32 v123, s75, v122
    ds_write_b128 v123, v[12:15] offset:35072
    s_lshl_b32 s75, s72, 3
    v_mov_b32 v123, s75
    ds_write_b64 v123, v[120:121] offset:39168
    s_waitcnt lgkmcnt(0)
    s_barrier
    v_mov_b32 v123, 0
    ds_read_b128 v[16:19], v123 offset:39168
    ds_read_b128 v[20:23], v123 offset:39184
    ds_read_b128 v[24:27], v123 offset:39200
    ds_read_b128 v[28:31], v123 offset:39216
    s_lshl_b32 s75, s72, 6
    v_lshlrev_b32 v123, 4, v3
    v_add_u32 v123, s75, v123
    ds_read_b128 v[32:35], v123 offset:35072
    ds_read_b128 v[36:39], v123 offset:35584
    ds_read_b128 v[40:43], v123 offset:36096
    ds_read_b128 v[44:47], v123 offset:36608
    ds_read_b128 v[48:51], v123 offset:37120
    ds_read_b128 v[52:55], v123 offset:37632
    ds_read_b128 v[56:59], v123 offset:38144
    ds_read_b128 v[60:63], v123 offset:38656
    s_waitcnt lgkmcnt(8)
    v_max3_f32 v124, v16, v18, v20
    v_max3_f32 v124, v124, v22, v24
    v_max3_f32 v124, v124, v26, v28
    v_max_f32 v124, v124, v30
    v_sub_f32 v16, v16, v124
    v_sub_f32 v18, v18, v124
    v_sub_f32 v20, v20, v124
    v_sub_f32 v22, v22, v124
    v_sub_f32 v24, v24, v124
    v_sub_f32 v26, v26, v124
    v_sub_f32 v28, v28, v124
    v_sub_f32 v30, v30, v124
    v_exp_f32 v16, v16
    v_exp_f32 v18, v18
    v_exp_f32 v20, v20
    v_exp_f32 v22, v22
    v_exp_f32 v24, v24
    v_exp_f32 v26, v26
    v_exp_f32 v28, v28
    v_exp_f32 v30, v30
    s_nop 0
    v_mul_f32 v123, v16, v17
    v_fmac_f32 v123, v18, v19
    v_fmac_f32 v123, v20, v21
    v_fmac_f32 v123, v22, v23
    v_fmac_f32 v123, v24, v25
    v_fmac_f32 v123, v26, v27
    v_fmac_f32 v123, v28, v29
    v_fmac_f32 v123, v30, v31
    v_rcp_f32 v124, v123
    s_nop 0
    v_fma_f32 v125, -v123, v124, 2.0
    v_mul_f32 v124, v124, v125
    v_mul_f32 v16, v16, v124
    v_mul_f32 v18, v18, v124
    v_mul_f32 v20, v20, v124
    v_mul_f32 v22, v22, v124
    v_mul_f32 v24, v24, v124
    v_mul_f32 v26, v26, v124
    v_mul_f32 v28, v28, v124
    v_mul_f32 v30, v30, v124
    s_waitcnt lgkmcnt(0)
    v_mul_f32 v12, v32, v16
    v_mul_f32 v13, v33, v16
    v_mul_f32 v14, v34, v16
    v_mul_f32 v15, v35, v16
    v_fmac_f32 v12, v36, v18
    v_fmac_f32 v13, v37, v18
    v_fmac_f32 v14, v38, v18
    v_fmac_f32 v15, v39, v18
    v_fmac_f32 v12, v40, v20
    v_fmac_f32 v13, v41, v20
    v_fmac_f32 v14, v42, v20
    v_fmac_f32 v15, v43, v20
    v_fmac_f32 v12, v44, v22
    v_fmac_f32 v13, v45, v22
    v_fmac_f32 v14, v46, v22
    v_fmac_f32 v15, v47, v22
    v_fmac_f32 v12, v48, v24
    v_fmac_f32 v13, v49, v24
    v_fmac_f32 v14, v50, v24
    v_fmac_f32 v15, v51, v24
    v_fmac_f32 v12, v52, v26
    v_fmac_f32 v13, v53, v26
    v_fmac_f32 v14, v54, v26
    v_fmac_f32 v15, v55, v26
    v_fmac_f32 v12, v56, v28
    v_fmac_f32 v13, v57, v28
    v_fmac_f32 v14, v58, v28
    v_fmac_f32 v15, v59, v28
    v_fmac_f32 v12, v60, v30
    v_fmac_f32 v13, v61, v30
    v_fmac_f32 v14, v62, v30
    v_fmac_f32 v15, v63, v30
    v_cvt_pk_bf16_f32 v12, v12, v12
    v_cvt_pk_bf16_f32 v13, v13, v13
    v_cvt_pk_bf16_f32 v14, v14, v14
    v_cvt_pk_bf16_f32 v15, v15, v15
    v_and_b32 v104, v12, v8
    v_and_b32 v105, v12, v9
    v_and_b32 v106, v12, v10
    v_and_b32 v107, v12, v11
    v_and_b32 v108, v13, v8
    v_and_b32 v109, v13, v9
    v_and_b32 v110, v13, v10
    v_and_b32 v111, v13, v11
    v_and_b32 v112, v14, v8
    v_and_b32 v113, v14, v9
    v_and_b32 v114, v14, v10
    v_and_b32 v115, v14, v11
    v_and_b32 v116, v15, v8
    v_and_b32 v117, v15, v9
    v_and_b32 v118, v15, v10
    v_and_b32 v119, v15, v11
    s_waitcnt vmcnt(0)
    v_mfma_f32_16x16x32_bf16 v[64:67], v[104:107], v[128:131], 0
    v_mfma_f32_16x16x32_bf16 v[68:71], v[104:107], v[132:135], 0
    v_mfma_f32_16x16x32_bf16 v[72:75], v[104:107], v[136:139], 0
    v_mfma_f32_16x16x32_bf16 v[76:79], v[104:107], v[140:143], 0
    v_mfma_f32_16x16x32_bf16 v[80:83], v[104:107], v[144:147], 0
    v_mfma_f32_16x16x32_bf16 v[64:67], v[108:111], v[148:151], v[64:67]
    v_mfma_f32_16x16x32_bf16 v[68:71], v[108:111], v[152:155], v[68:71]
    v_mfma_f32_16x16x32_bf16 v[72:75], v[108:111], v[156:159], v[72:75]
    v_mfma_f32_16x16x32_bf16 v[76:79], v[108:111], v[160:163], v[76:79]
    v_mfma_f32_16x16x32_bf16 v[80:83], v[108:111], v[164:167], v[80:83]
    v_mfma_f32_16x16x32_bf16 v[64:67], v[112:115], v[168:171], v[64:67]
    v_mfma_f32_16x16x32_bf16 v[68:71], v[112:115], v[172:175], v[68:71]
    v_mfma_f32_16x16x32_bf16 v[72:75], v[112:115], v[176:179], v[72:75]
    v_mfma_f32_16x16x32_bf16 v[76:79], v[112:115], v[180:183], v[76:79]
    v_mfma_f32_16x16x32_bf16 v[80:83], v[112:115], v[184:187], v[80:83]
    v_mfma_f32_16x16x32_bf16 v[64:67], v[116:119], v[188:191], v[64:67]
    v_mfma_f32_16x16x32_bf16 v[68:71], v[116:119], v[192:195], v[68:71]
    v_mfma_f32_16x16x32_bf16 v[72:75], v[116:119], v[196:199], v[72:75]
    v_mfma_f32_16x16x32_bf16 v[76:79], v[116:119], v[200:203], v[76:79]
    v_mfma_f32_16x16x32_bf16 v[80:83], v[116:119], v[204:207], v[80:83]
    s_mul_i32 s75, s72, 2560
    v_add_u32 v124, s75, v122
    s_nop 7
    ds_write_b128 v124, v[64:67] offset:39936
    ds_write_b128 v124, v[68:71] offset:40448
    ds_write_b128 v124, v[72:75] offset:40960
    ds_write_b128 v124, v[76:79] offset:41472
    ds_write_b128 v124, v[80:83] offset:41984
    s_waitcnt lgkmcnt(0)
    s_barrier
    s_cmp_ge_u32 s86, 108
    s_cbranch_scc1 L_noz
    s_mul_i32 s73, s86, 20480
    s_add_u32 s73, s73, 655360
    s_add_u32 s68, s28, s73
    s_addc_u32 s69, s29, 0
    s_and_b32 s69, s69, 0xffff
    s_mov_b32 s70, 20480
    s_mov_b32 s71, 0x00020000
    v_lshlrev_b32 v125, 4, v0
    v_add_u32 v126, 60416, v125
    ds_read_b128 v[128:131], v126 offset:0
    ds_read_b128 v[132:135], v126 offset:8192
    ds_read_b128 v[136:139], v126 offset:16384
    s_waitcnt lgkmcnt(0)
    s_mov_b32 s73, 0
    buffer_store_dwordx4 v[128:131], v125, s[68:71], s73 offen
    s_mov_b32 s73, 8192
    buffer_store_dwordx4 v[132:135], v125, s[68:71], s73 offen
    s_mov_b32 s73, 16384
    buffer_store_dwordx4 v[136:139], v125, s[68:71], s73 offen
L_noz:
    v_cmp_gt_u32 vcc, 160, v0
    s_and_saveexec_b64 s[84:85], vcc
    s_cbranch_execz L_a_end
    v_lshlrev_b32 v124, 4, v0
    ds_read_b128 v[32:35], v124 offset:39936
    ds_read_b128 v[36:39], v124 offset:42496
    ds_read_b128 v[40:43], v124 offset:45056
    ds_read_b128 v[44:47], v124 offset:47616
    ds_read_b128 v[48:51], v124 offset:50176
    ds_read_b128 v[52:55], v124 offset:52736
    ds_read_b128 v[56:59], v124 offset:55296
    ds_read_b128 v[60:63], v124 offset:57856
    s_waitcnt lgkmcnt(0)
    v_add_f32 v32, v32, v36
    v_add_f32 v33, v33, v37
    v_add_f32 v34, v34, v38
    v_add_f32 v35, v35, v39
    v_add_f32 v32, v32, v40
    v_add_f32 v33, v33, v41
    v_add_f32 v34, v34, v42
    v_add_f32 v35, v35, v43
    v_add_f32 v32, v32, v44
    v_add_f32 v33, v33, v45
    v_add_f32 v34, v34, v46
    v_add_f32 v35, v35, v47
    v_add_f32 v32, v32, v48
    v_add_f32 v33, v33, v49
    v_add_f32 v34, v34, v50
    v_add_f32 v35, v35, v51
    v_add_f32 v32, v32, v52
    v_add_f32 v33, v33, v53
    v_add_f32 v34, v34, v54
    v_add_f32 v35, v35, v55
    v_add_f32 v32, v32, v56
    v_add_f32 v33, v33, v57
    v_add_f32 v34, v34, v58
    v_add_f32 v35, v35, v59
    v_add_f32 v32, v32, v60
    v_add_f32 v33, v33, v61
    v_add_f32 v34, v34, v62
    v_add_f32 v35, v35, v63
    buffer_store_dwordx4 v[32:35], v124, s[52:55], 0 offen
L_a_end:
    s_endpgm
.globl final_kernel
.p2align 8
.type final_kernel,@function
final_kernel:
    s_cmp_ge_u32 s2, 80
    s_cbranch_scc1 L_b_end
    s_load_dwordx2 s[4:5], s[0:1], 0
    s_load_dwordx4 s[20:23], s[0:1], 64
    s_load_dwordx2 s[24:25], s[0:1], 80
    s_load_dwordx2 s[28:29], s[0:1], 96
    s_mul_i32 s60, s2, 205
    s_lshr_b32 s60, s60, 11
    s_mul_i32 s61, s60, 10
    s_sub_u32 s61, s2, s61
    v_and_b32 v1, 15, v0
    v_lshrrev_b32 v2, 4, v0
    s_lshl_b32 s62, s61, 8
    v_mul_u32_u24 v3, 5120, v2
    v_lshl_add_u32 v3, v1, 4, v3
    s_mul_i32 s63, s60, 81920
    s_add_u32 s63, s63, s62
    v_mul_u32_u24 v4, 20480, v2
    v_lshl_add_u32 v4, v1, 4, v4
    s_mul_i32 s64, s60, 2560
    s_add_u32 s64, s64, s62
    s_waitcnt lgkmcnt(0)
    s_mov_b32 s32, s28
    s_and_b32 s33, s29, 0xffff
    s_mov_b32 s34, 655360
    s_mov_b32 s35, 0x00020000
    s_mov_b32 s65, 655360
    s_add_u32 s36, s28, s65
    s_addc_u32 s37, s29, 0
    s_and_b32 s37, s37, 0xffff
    s_mov_b32 s38, 2211840
    s_mov_b32 s39, 0x00020000
    s_mov_b32 s40, s4
    s_and_b32 s41, s5, 0xffff
    s_mov_b32 s42, 10240
    s_mov_b32 s43, 0x00020000
    s_mov_b32 s44, s22
    s_and_b32 s45, s23, 0xffff
    s_mov_b32 s46, 1280
    s_mov_b32 s47, 0x00020000
    s_mov_b32 s48, s24
    s_and_b32 s49, s25, 0xffff
    s_mov_b32 s50, 10240
    s_mov_b32 s51, 0x00020000
    buffer_load_dwordx4 v[8:11], v3, s[32:35], s63 offen
    buffer_load_dwordx4 v[12:15], v3, s[32:35], s63 offen offset:2560
    buffer_load_dwordx4 v[16:19], v4, s[36:39], s64 offen
    s_add_u32 s64, s64, 327680
    buffer_load_dwordx4 v[20:23], v4, s[36:39], s64 offen
    s_add_u32 s64, s64, 327680
    buffer_load_dwordx4 v[24:27], v4, s[36:39], s64 offen
    s_add_u32 s64, s64, 327680
    buffer_load_dwordx4 v[28:31], v4, s[36:39], s64 offen
    s_add_u32 s64, s64, 327680
    buffer_load_dwordx4 v[32:35], v4, s[36:39], s64 offen
    s_add_u32 s64, s64, 327680
    buffer_load_dwordx4 v[36:39], v4, s[36:39], s64 offen
    s_add_u32 s64, s64, 327680
    buffer_load_dwordx4 v[40:43], v4, s[36:39], s64 offen
    s_add_u32 s64, s64, 327680
    s_lshl_b32 s66, s61, 7
    s_mul_i32 s67, s60, 1280
    s_add_u32 s67, s67, s66
    v_and_b32 v5, 63, v0
    v_lshlrev_b32 v5, 1, v5
    buffer_load_ushort v44, v5, s[40:43], s67 offen
    buffer_load_ushort v45, v5, s[44:47], s66 offen
    s_waitcnt vmcnt(9)
    v_add_f32 v8, v8, v12
    v_add_f32 v9, v9, v13
    v_add_f32 v10, v10, v14
    v_add_f32 v11, v11, v15
    s_waitcnt vmcnt(2)
    v_add_f32 v16, v16, v20
    v_add_f32 v17, v17, v21
    v_add_f32 v18, v18, v22
    v_add_f32 v19, v19, v23
    v_add_f32 v16, v16, v24
    v_add_f32 v17, v17, v25
    v_add_f32 v18, v18, v26
    v_add_f32 v19, v19, v27
    v_add_f32 v16, v16, v28
    v_add_f32 v17, v17, v29
    v_add_f32 v18, v18, v30
    v_add_f32 v19, v19, v31
    v_add_f32 v16, v16, v32
    v_add_f32 v17, v17, v33
    v_add_f32 v18, v18, v34
    v_add_f32 v19, v19, v35
    v_add_f32 v16, v16, v36
    v_add_f32 v17, v17, v37
    v_add_f32 v18, v18, v38
    v_add_f32 v19, v19, v39
    v_add_f32 v16, v16, v40
    v_add_f32 v17, v17, v41
    v_add_f32 v18, v18, v42
    v_add_f32 v19, v19, v43
    v_lshlrev_b32 v6, 4, v0
    ds_write_b128 v6, v[8:11]
    ds_write_b128 v6, v[16:19] offset:4096
    s_waitcnt lgkmcnt(0)
    s_barrier
    v_cmp_gt_u32 vcc, 64, v0
    s_and_saveexec_b64 s[68:69], vcc
    s_cbranch_execz L_b_end
    v_lshlrev_b32 v6, 2, v0
    ds_read_b32 v8, v6 offset:0
    ds_read_b32 v9, v6 offset:256
    ds_read_b32 v10, v6 offset:512
    ds_read_b32 v11, v6 offset:768
    ds_read_b32 v12, v6 offset:1024
    ds_read_b32 v13, v6 offset:1280
    ds_read_b32 v14, v6 offset:1536
    ds_read_b32 v15, v6 offset:1792
    ds_read_b32 v16, v6 offset:2048
    ds_read_b32 v17, v6 offset:2304
    ds_read_b32 v18, v6 offset:2560
    ds_read_b32 v19, v6 offset:2816
    ds_read_b32 v20, v6 offset:3072
    ds_read_b32 v21, v6 offset:3328
    ds_read_b32 v22, v6 offset:3584
    ds_read_b32 v23, v6 offset:3840
    ds_read_b32 v24, v6 offset:4096
    ds_read_b32 v25, v6 offset:4352
    ds_read_b32 v26, v6 offset:4608
    ds_read_b32 v27, v6 offset:4864
    ds_read_b32 v28, v6 offset:5120
    ds_read_b32 v29, v6 offset:5376
    ds_read_b32 v30, v6 offset:5632
    ds_read_b32 v31, v6 offset:5888
    ds_read_b32 v32, v6 offset:6144
    ds_read_b32 v33, v6 offset:6400
    ds_read_b32 v34, v6 offset:6656
    ds_read_b32 v35, v6 offset:6912
    ds_read_b32 v36, v6 offset:7168
    ds_read_b32 v37, v6 offset:7424
    ds_read_b32 v38, v6 offset:7680
    ds_read_b32 v39, v6 offset:7936
    s_waitcnt lgkmcnt(0)
    v_add_f32 v8, v8, v9
    v_add_f32 v24, v24, v25
    v_add_f32 v8, v8, v10
    v_add_f32 v24, v24, v26
    v_add_f32 v8, v8, v11
    v_add_f32 v24, v24, v27
    v_add_f32 v8, v8, v12
    v_add_f32 v24, v24, v28
    v_add_f32 v8, v8, v13
    v_add_f32 v24, v24, v29
    v_add_f32 v8, v8, v14
    v_add_f32 v24, v24, v30
    v_add_f32 v8, v8, v15
    v_add_f32 v24, v24, v31
    v_add_f32 v8, v8, v16
    v_add_f32 v24, v24, v32
    v_add_f32 v8, v8, v17
    v_add_f32 v24, v24, v33
    v_add_f32 v8, v8, v18
    v_add_f32 v24, v24, v34
    v_add_f32 v8, v8, v19
    v_add_f32 v24, v24, v35
    v_add_f32 v8, v8, v20
    v_add_f32 v24, v24, v36
    v_add_f32 v8, v8, v21
    v_add_f32 v24, v24, v37
    v_add_f32 v8, v8, v22
    v_add_f32 v24, v24, v38
    v_add_f32 v8, v8, v23
    v_add_f32 v24, v24, v39
    s_waitcnt vmcnt(0)
    v_cvt_pk_bf16_f32 v8, v8, v8
    v_and_b32 v8, 0xffff0000, v8
    v_cvt_pk_bf16_f32 v24, v24, v24
    v_and_b32 v24, 0xffff0000, v24
    v_lshlrev_b32 v45, 16, v45
    v_lshlrev_b32 v44, 16, v44
    v_add_f32 v24, v24, v45
    v_cvt_pk_bf16_f32 v24, v24, v24
    v_and_b32 v24, 0xffff0000, v24
    v_mul_f32 v25, 0xbfb8aa3b, v24
    v_exp_f32 v25, v25
    s_nop 0
    v_add_f32 v25, 1.0, v25
    v_rcp_f32 v26, v25
    s_nop 0
    v_mul_f32 v24, v24, v26
    v_cvt_pk_bf16_f32 v24, v24, v24
    v_and_b32 v24, 0xffff0000, v24
    v_mul_f32 v8, v8, v24
    v_cvt_pk_bf16_f32 v8, v8, v8
    v_and_b32 v8, 0xffff0000, v8
    v_add_f32 v8, v8, v44
    v_cvt_pk_bf16_f32 v8, v8, v8
    buffer_store_short v8, v5, s[48:51], s67 offen
L_b_end:
    s_endpgm
.section .rodata,"a"
.p2align 6
.amdhsa_kernel attn_ffn_kernel
  .amdhsa_next_free_vgpr 256
  .amdhsa_next_free_sgpr 102
  .amdhsa_accum_offset 256
  .amdhsa_group_segment_fixed_size 0
  .amdhsa_kernarg_size 104
  .amdhsa_user_sgpr_count 2
  .amdhsa_user_sgpr_kernarg_segment_ptr 1
  .amdhsa_system_sgpr_workgroup_id_x 1
  .amdhsa_float_denorm_mode_32 3
.end_amdhsa_kernel
.p2align 6
.amdhsa_kernel final_kernel
  .amdhsa_next_free_vgpr 48
  .amdhsa_next_free_sgpr 72
  .amdhsa_accum_offset 48
  .amdhsa_group_segment_fixed_size 0
  .amdhsa_kernarg_size 104
  .amdhsa_user_sgpr_count 2
  .amdhsa_user_sgpr_kernarg_segment_ptr 1
  .amdhsa_system_sgpr_workgroup_id_x 1
  .amdhsa_float_denorm_mode_32 3
.end_amdhsa_kernel
```
